```python
import torch

def _softmax(x, axis=-1):
    return torch.softmax(x, dim=axis)
def _gelu(x):
    return torch.nn.functional.gelu(x, approximate="tanh")
def _silu(x):
    return torch.nn.functional.silu(x)
def _sigmoid(x):
    return torch.sigmoid(x)
def _layernorm(x, axis=-1, eps=1e-5):
    m = x.mean(dim=axis, keepdim=True)
    v = x.var(dim=axis, keepdim=True, unbiased=False)
    return (x - m) / torch.sqrt(v + eps)
def _scatter_add(tgt, idx, src, axis=0):
    return tgt.clone().index_add_(axis, idx, src)
def _segment_sum(src, seg, n):
    out = torch.zeros((n,) + src.shape[1:], dtype=src.dtype)
    return out.index_add_(0, seg, src)
def _pad(x, pw):
    flat = tuple(v for pair in reversed(pw) for v in pair)
    return torch.nn.functional.pad(x, flat)

kernel_name = 'parallel_sum__linear_attn_block__glu_gated_bilinear__prompt'

def setup_inputs():

    _w = (lambda a: (lambda t: t.to(torch.bfloat16) if t.is_floating_point() else t)(torch.as_tensor(a)))
    def _A_setup():
        B, S, D = 1, 2048, 640
        return {
            "x": _w((lambda *s: torch.randn(*s, dtype=torch.bfloat16) * 0.05)(B, S, D)),
            "wqkv": _w((lambda *s: torch.randn(*s, dtype=torch.bfloat16) * 0.05)(D, 3 * D)),
            "wo": _w((lambda *s: torch.randn(*s, dtype=torch.bfloat16) * 0.05)(D, D)),
        }
    _A_in = _A_setup()

    def _B_setup():
        B, S, D, F = 1, 2048, 640, 1728
        return {
            "x": _w((lambda *s: torch.randn(*s, dtype=torch.bfloat16) * 0.05)(B, S, D)),
            "w_gate": _w((lambda *s: torch.randn(*s, dtype=torch.bfloat16) * 0.2)(D, F) * (D ** -0.5)),
            "w_up": _w((lambda *s: torch.randn(*s, dtype=torch.bfloat16) * 0.2)(D, F) * (D ** -0.5)),
            "w_down": _w((lambda *s: torch.randn(*s, dtype=torch.bfloat16) * 0.2)(F, D) * (F ** -0.5)),
        }
    _B_in = _B_setup()

    return {
        "A_x": _A_in["x"],
        "A_wqkv": _A_in["wqkv"],
        "A_wo": _A_in["wo"],
        "B_x": _B_in["x"],
        "B_w_gate": _B_in["w_gate"],
        "B_w_up": _B_in["w_up"],
        "B_w_down": _B_in["w_down"],
    }

def reference(A_x, A_wqkv, A_wo, B_x, B_w_gate, B_w_up, B_w_down):
    def _A_ref(x, wqkv, wo):
        B, S, D = x.shape
        H = 32; Dh = D // H
        qkv = (lambda x, *d: x.permute(*d))((x @ wqkv).reshape(B, S, 3, H, Dh), 2, 0, 3, 1, 4)
        q, k, v = qkv[0], qkv[1], qkv[2]
        phi = lambda t: torch.where(t > 0, t + 1, torch.exp(t)) + 1e-6
        pq, pk = phi(q), phi(k)
        kv = torch.einsum("bhsd,bhse->bhde", pk, v)
        z = torch.einsum("bhsd->bhd", pk)
        num = torch.einsum("bhqd,bhde->bhqe", pq, kv)
        den = torch.einsum("bhqd,bhd->bhq", pq, z)[..., None] + 1e-6
        o = num / den
        return (lambda x, *d: x.permute(*d))(o, 0, 2, 1, 3).reshape(B, S, D) @ wo

    def _B_ref(x, w_gate, w_up, w_down):
        g = torch.einsum("bsd,df->bsf", x, w_gate)
        u = torch.einsum("bsd,df->bsf", x, w_up)
        h = g * u
        return torch.einsum("bsf,fd->bsd", h, w_down)

    x = A_x
    xn = _layernorm(x, axis=-1)
    return x + _A_ref(xn, A_wqkv, A_wo) + _B_ref(xn, B_w_gate, B_w_up, B_w_down)
```

```asm
; @launch kernel=k1_kernel grid=(256,1,1) block=(256,1,1) lds=163840
; @launch kernel=k2_kernel grid=(256,1,1) block=(512,1,1) lds=126976
.amdgcn_target "amdgcn-amd-amdhsa--gfx950"
.text
.globl k1_kernel
.p2align 8
.type k1_kernel,@function
k1_kernel:
  s_cmp_ge_u32 s2, 256
  s_cbranch_scc1 L_k1_kernel_end
  s_load_dwordx16 s[52:67], s[0:1], 0
  s_load_dwordx4 s[68:71], s[0:1], 64
  v_and_b32 v244, 63, v0
  v_lshrrev_b32 v220, 6, v0
  v_and_b32 v245, 15, v244
  v_readfirstlane_b32 s20, v220
  v_lshrrev_b32 v246, 4, v244
  s_getpc_b64 s[46:47]
L_k1_kernel_pc:
  s_lshr_b32 s22, s2, 3
  s_mul_i32 s22, s22, 1024
  v_min_u32 v240, 7, v244
  v_lshlrev_b32 v240, 7, v240
  v_add_u32 v240, s22, v240
  s_mov_b32 s22, L_code_end-L_k1_kernel_pc-4
  v_min_u32 v240, s22, v240
  global_load_dword v241, v240, s[46:47]
  s_and_b32 s22, s2, 7
  s_xor_b32 s22, s22, 4
  s_lshr_b32 s23, s2, 3
  s_lshl_b32 s22, s22, 5
  s_add_u32 s23, s23, s22
  s_mul_i32 s31, s23, 43691
  s_lshr_b32 s31, s31, 19
  s_mul_i32 s32, s31, 12
  s_sub_u32 s32, s23, s32
  s_mul_i32 s21, s32, 172
  s_max_u32 s22, s32, 8
  s_sub_u32 s22, s22, 8
  s_lshl_b32 s22, s22, 2
  s_sub_u32 s21, s21, s22
  s_and_b32 s51, s20, 1
  s_lshr_b32 s72, s20, 1
  s_cmp_lt_u32 s31, 13
  s_cbranch_scc1 L_k1_kernel_srcF
  s_cmp_eq_u32 s31, 13
  s_cbranch_scc1 L_k1_kernel_srcM
  s_mov_b32 s38, 2
  s_sub_u32 s39, s31, 14
  s_lshl_b32 s39, s39, 8
  s_lshl_b32 s22, s20, 6
  s_add_u32 s39, s39, s22
  s_mov_b32 s30, 1
  s_branch L_k1_kernel_srcdone
L_k1_kernel_srcF:
  s_mov_b32 s38, s72
  s_lshl_b32 s39, s31, 7
  s_lshl_b32 s22, s51, 6
  s_add_u32 s39, s39, s22
  s_mov_b32 s30, 0
  s_branch L_k1_kernel_srcdone
L_k1_kernel_srcM:
  s_lshl_b32 s22, s72, 6
  s_add_u32 s22, s22, 1792
  s_cmp_eq_u32 s51, 1
  s_cselect_b32 s39, s22, 1664
  s_cselect_b32 s38, 2, s72
  s_mov_b32 s30, s72
L_k1_kernel_srcdone:
  s_mov_b32 s50, 3456
  s_cmp_eq_u32 s38, 2
  s_cselect_b32 s50, 3840, s50
  s_lshl_b32 s25, s50, 5
  v_lshrrev_b32 v234, 3, v244
  v_mul_lo_u32 v235, s50, v234
  v_bfe_u32 v237, v244, 1, 2
  v_bfe_u32 v238, v244, 4, 1
  v_and_b32 v239, 1, v244
  v_lshl_add_u32 v235, v239, 4, v235
  s_lshl_b32 s22, s39, 1
  v_add_u32 v235, s22, v235
  v_xor_b32 v237, v237, v238
  v_lshl_add_u32 v182, v237, 5, v235
  v_xor_b32 v237, 2, v237
  v_lshl_add_u32 v183, v237, 5, v235
  s_lshl_b32 s22, s50, 3
  s_sub_u32 s22, s22, 1024
  v_add_u32 v183, s22, v183
  s_lshl_b32 s22, s22, 1
  v_add_u32 v184, s22, v182
  v_add_u32 v185, s22, v183
  s_lshl_b32 s22, s20, 2
  v_add_u32 v235, s22, v246
  v_xor_b32 v237, v245, v235
  v_add_u32 v235, s21, v235
  v_mul_u32_u24 v235, 1280, v235
  v_lshl_add_u32 v186, v237, 4, v235
  v_add_u32 v187, 204800, v186
  s_lshl_b32 s27, s20, 10
  s_lshl_b32 s26, s20, 12
  s_add_u32 s26, s26, 90112
  s_lshl_b32 s22, s2, 3
  s_lshl_b32 s23, s20, 1
  s_add_u32 s22, s22, s23
  v_lshrrev_b32 v220, 5, v244
  v_add_u32 v220, s22, v220
  v_mul_u32_u24 v221, 1280, v220
  v_and_b32 v222, 31, v244
  v_lshl_add_u32 v221, v222, 3, v221
  v_lshlrev_b32 v242, 3, v220
  s_waitcnt lgkmcnt(0)
  s_mov_b32 s4, s52
  s_mov_b32 s5, s53
  s_mov_b32 s6, 2621440
  s_mov_b32 s7, 0x20000
  buffer_load_dwordx2 v[222:223], v221, s[4:7], 0 offen offset:0
  buffer_load_dwordx2 v[224:225], v221, s[4:7], 0 offen offset:256
  buffer_load_dwordx2 v[226:227], v221, s[4:7], 0 offen offset:512
  buffer_load_dwordx2 v[228:229], v221, s[4:7], 0 offen offset:768
  buffer_load_dwordx2 v[230:231], v221, s[4:7], 0 offen offset:1024
  s_cmp_eq_u32 s38, 0
  s_cselect_b32 s8, s60, s62
  s_cselect_b32 s9, s61, s63
  s_cmp_eq_u32 s38, 2
  s_cselect_b32 s8, s54, s8
  s_cselect_b32 s9, s55, s9
  s_mul_i32 s10, s50, 640
  s_mov_b32 s11, 0x20000
  s_add_u32 s12, s70, 0
  s_addc_u32 s13, s71, 0
  s_mov_b32 s14, 268435456
  s_mov_b32 s15, 0x20000
  s_mov_b32 s16, s68
  s_mov_b32 s17, s69
  s_mov_b32 s18, 256
  s_mov_b32 s19, 0x20000
  s_mov_b32 s34, 23068672
  s_mul_i32 s23, s31, 12
  s_add_u32 s23, s23, s32
  s_cmp_lt_u32 s23, 180
  s_cselect_b32 s64, s64, s56
  s_cselect_b32 s65, s65, s57
  s_mov_b32 s66, 2211840
  s_cselect_b32 s66, s66, 819200
  s_mov_b32 s67, 0x20000
  s_cmp_ge_u32 s31, 21
  s_cbranch_scc1 L_k1_kernel_spare
  s_add_u32 s62, s31, s32
  s_mul_i32 s22, s62, 52429
  s_lshr_b32 s22, s22, 18
  s_mul_i32 s22, s22, 5
  s_sub_u32 s62, s62, s22
  s_lshl_b32 s52, s62, 8
  s_mul_i32 s22, s62, s25
  s_lshl_b32 s57, s22, 2
  s_add_u32 s62, s62, 1
  s_cmp_eq_u32 s62, 5
  s_cselect_b32 s62, 0, s62
  s_lshl_b32 s53, s62, 8
  s_mul_i32 s22, s62, s25
  s_lshl_b32 s58, s22, 2
  s_add_u32 s62, s62, 1
  s_cmp_eq_u32 s62, 5
  s_cselect_b32 s62, 0, s62
  s_lshl_b32 s54, s62, 8
  s_mul_i32 s22, s62, s25
  s_lshl_b32 s59, s22, 2
  s_add_u32 s62, s62, 1
  s_cmp_eq_u32 s62, 5
  s_cselect_b32 s62, 0, s62
  s_lshl_b32 s55, s62, 8
  s_mul_i32 s22, s62, s25
  s_lshl_b32 s60, s22, 2
  s_add_u32 s62, s62, 1
  s_cmp_eq_u32 s62, 5
  s_cselect_b32 s62, 0, s62
  s_lshl_b32 s56, s62, 8
  s_mul_i32 s22, s62, s25
  s_lshl_b32 s61, s22, 2
  s_add_u32 m0, s26, 0
  s_mov_b32 s24, s57
  buffer_load_dwordx4 v182, s[8:11], s24 offen offset:0  lds
  buffer_load_dwordx4 v183, s[8:11], s24 offen offset:1024  lds
  buffer_load_dwordx4 v184, s[8:11], s24 offen offset:2048  lds
  buffer_load_dwordx4 v185, s[8:11], s24 offen offset:3072  lds
  s_add_u32 m0, s27, 0
  s_nop 0
  buffer_load_dwordx4 v187, s[4:7], s52 offen  lds
  s_add_u32 m0, s27, 8192
  s_add_u32 s28, s52, 184320
  buffer_load_dwordx4 v186, s[4:7], s28 offen  lds
  s_add_u32 m0, s27, 16384
  s_add_u32 s28, s52, 163840
  buffer_load_dwordx4 v186, s[4:7], s28 offen  lds
  v_lshrrev_b32 v234, 2, v245
  v_lshlrev_b32 v234, 10, v234
  v_and_b32 v235, 3, v245
  v_lshl_add_u32 v234, v235, 8, v234
  v_xor_b32 v235, v246, v245
  v_lshl_add_u32 v188, v235, 4, v234
  v_xor_b32 v189, 64, v188
  v_xor_b32 v190, 128, v188
  v_xor_b32 v191, 192, v188
  v_add_u32 v192, 45056, v188
  v_add_u32 v193, 45056, v189
  v_add_u32 v194, 45056, v190
  v_add_u32 v195, 45056, v191
  v_bfe_u32 v234, v244, 2, 2
  v_and_b32 v235, 3, v244
  v_lshl_add_u32 v236, v246, 3, v234
  v_lshlrev_b32 v236, 7, v236
  s_lshl_b32 s22, s72, 12
  s_add_u32 s22, s22, 90112
  v_add_u32 v236, s22, v236
  v_lshrrev_b32 v237, 1, v234
  v_and_b32 v238, 1, v246
  v_lshl_or_b32 v237, v238, 1, v237
  s_lshl_b32 s22, s51, 1
  s_cmp_eq_u32 s30, 0
  s_cbranch_scc0 L_k1_kernel_wrP
  v_xor_b32 v238, s22, v237
  v_lshl_add_u32 v239, v238, 5, v236
  v_lshl_add_u32 v196, v235, 3, v239
  v_xor_b32 v238, 1, v238
  v_lshl_add_u32 v239, v238, 5, v236
  v_lshl_add_u32 v197, v235, 3, v239
  s_branch L_k1_kernel_wrdone
L_k1_kernel_wrP:
  v_lshrrev_b32 v238, 1, v235
  v_or_b32 v238, s22, v238
  v_xor_b32 v238, v238, v237
  v_lshl_add_u32 v239, v238, 5, v236
  v_and_b32 v238, 1, v235
  v_lshl_add_u32 v196, v238, 4, v239
  v_add_u32 v197, 8, v196
L_k1_kernel_wrdone:
  s_add_u32 m0, s26, 16384
  s_add_u32 s24, s24, s25
  buffer_load_dwordx4 v182, s[8:11], s24 offen offset:0  lds
  buffer_load_dwordx4 v183, s[8:11], s24 offen offset:1024  lds
  buffer_load_dwordx4 v184, s[8:11], s24 offen offset:2048  lds
  buffer_load_dwordx4 v185, s[8:11], s24 offen offset:3072  lds
  s_add_u32 m0, s27, 24576
  s_add_u32 s28, s52, 143360
  buffer_load_dwordx4 v186, s[4:7], s28 offen  lds
  v_mov_b32 v180, 1073741824
  v_add_u32 v234, s21, v245
  v_lshlrev_b32 v202, 3, v234
  s_mov_b32 s29, 168
  s_cmp_lt_u32 s32, 8
  s_cselect_b32 s29, 172, s29
  s_sub_u32 s22, s29, 160
  v_cmp_gt_u32 s[44:45], s22, v245
  s_cmp_eq_u32 s30, 0
  s_cbranch_scc0 L_k1_kernel_stP
  s_lshl_b32 s22, s31, 2
  s_add_u32 s22, s22, s20
  s_lshl_b32 s22, s22, 10
  s_add_u32 s22, s22, 0
  v_lshrrev_b32 v235, 4, v234
  s_mov_b32 s23, 75776
  v_mul_lo_u32 v235, s23, v235
  v_and_b32 v236, 15, v234
  v_lshl_add_u32 v236, v246, 4, v236
  v_lshl_add_u32 v235, v236, 4, v235
  v_add_u32 v198, s22, v235
  v_mov_b32 v200, v198
  s_branch L_k1_kernel_stdone
L_k1_kernel_stP:
  s_sub_u32 s22, s31, 14
  s_lshl_b32 s22, s22, 8
  s_lshl_b32 s23, s72, 6
  s_add_u32 s22, s22, s23
  s_cmp_eq_u32 s31, 13
  s_cselect_b32 s22, 1792, s22
  s_cselect_b32 s37, 64, 128
  s_lshl_b32 s23, s51, 5
  s_add_u32 s22, s22, s23
  s_cmp_lt_u32 s22, 1280
  s_cselect_b32 s33, 1069066811, 0x3f800000
  s_lshr_b32 s22, s22, 3
  v_add_u32 v235, s22, v246
  v_lshlrev_b32 v235, 15, v235
  v_lshl_add_u32 v235, v234, 4, v235
  v_add_u32 v198, 14680064, v235
  s_lshl_b32 s37, s37, 12
  v_add_u32 v200, s37, v198
L_k1_kernel_stdone:
  v_cndmask_b32 v199, v180, v198, s[44:45]
  v_cndmask_b32 v201, v180, v200, s[44:45]
  s_lshr_b32 s35, s21, 5
  s_add_u32 s36, s21, s29
  s_sub_u32 s36, s36, 1
  s_lshr_b32 s36, s36, 5
  v_mov_b32 v181, 0x3f803f80
  v_cmp_eq_u32 s[68:69], 15, v245
  s_add_u32 m0, s26, 32768
  s_add_u32 s24, s24, s25
  buffer_load_dwordx4 v182, s[8:11], s24 offen offset:0  lds
  buffer_load_dwordx4 v183, s[8:11], s24 offen offset:1024  lds
  buffer_load_dwordx4 v184, s[8:11], s24 offen offset:2048  lds
  buffer_load_dwordx4 v185, s[8:11], s24 offen offset:3072  lds
  s_add_u32 m0, s27, 32768
  s_add_u32 s28, s52, 122880
  buffer_load_dwordx4 v186, s[4:7], s28 offen  lds
  s_mul_i32 s22, s31, 12
  s_add_u32 s22, s22, s32
  s_cmp_lt_u32 s22, 180
  s_cselect_b32 s71, 4, 1
  s_cselect_b32 s45, 2, 3
  s_lshl_b32 s71, s71, 9
  s_add_u32 s45, s45, 7
  v_lshrrev_b32 v234, 3, v244
  s_lshl_b32 s44, s20, 3
  v_add_u32 v234, s44, v234
  v_mul_u32_u24 v234, 1280, v234
  v_and_b32 v235, 7, v244
  v_lshl_add_u32 v255, v235, 4, v234
  v_lshlrev_b32 v254, 4, v244
  v_add_u32 v254, 10485760, v254
  v_lshlrev_b32 v234, s45, v246
  v_bfe_u32 v235, v244, 2, 2
  v_lshl_add_u32 v234, v235, 7, v234
  s_lshl_b32 s44, s72, 6
  s_add_u32 s44, s44, 90112
  v_add_u32 v234, s44, v234
  v_and_b32 v235, 3, v244
  s_lshl_b32 s44, s51, 3
  v_lshl_add_u32 v236, v235, 4, v234
  v_add_u32 v236, s44, v236
  s_lshl_b32 s44, s51, 5
  v_lshl_add_u32 v237, v235, 3, v234
  v_add_u32 v237, s44, v237
  s_mul_i32 s23, s22, 3
  s_add_u32 s23, s23, 0
  s_mul_i32 s28, s23, 52429
  s_lshr_b32 s28, s28, 19
  s_mul_i32 s44, s28, 10
  s_sub_u32 s44, s23, s44
  s_lshl_b32 s45, s44, 1
  s_add_u32 s45, s45, s72
  s_mul_i32 s48, s45, 52429
  s_lshr_b32 s48, s48, 18
  s_mul_i32 s48, s48, 5
  s_sub_u32 s45, s45, s48
  s_cmp_eq_u32 s45, 2
  s_cselect_b64 vcc, -1, 0
  v_cndmask_b32 v250, v236, v237, vcc
  v_add_u32 v250, 0, v250
  s_lshl_b32 s45, s44, 2
  s_add_u32 s45, s45, s20
  s_mul_i32 s45, s45, 74
  s_add_u32 s45, s45, s28
  s_lshl_b32 s94, s45, 10
  s_sub_u32 s45, s28, 54
  s_mul_i32 s45, s45, 40
  s_lshl_b32 s48, s72, 3
  s_add_u32 s45, s45, s48
  s_lshl_b32 s48, s28, 5
  s_cmp_ge_u32 s28, 54
  s_cselect_b32 s45, s45, s48
  s_sub_u32 s48, s28, 70
  s_mul_i32 s48, s48, 160
  s_mul_i32 s98, s20, 12
  s_add_u32 s48, s48, s98
  s_add_u32 s48, s48, 16
  s_lshl_b32 s98, s51, 4
  s_sub_u32 s48, s48, s98
  s_cmp_ge_u32 s28, 70
  s_cselect_b32 s45, s48, s45
  s_cselect_b32 s98, 97280, 0
  s_mul_i32 s45, s45, 1280
  s_lshl_b32 s44, s44, 7
  s_add_u32 s90, s45, s44
  s_cmp_ge_u32 s23, 740
  s_cselect_b32 s90, 1073741824, s90
  s_cselect_b32 s94, 1073741824, s94
  s_mul_i32 s23, s22, 3
  s_add_u32 s23, s23, 1
  s_mul_i32 s28, s23, 52429
  s_lshr_b32 s28, s28, 19
  s_mul_i32 s44, s28, 10
  s_sub_u32 s44, s23, s44
  s_lshl_b32 s45, s44, 1
  s_add_u32 s45, s45, s72
  s_mul_i32 s48, s45, 52429
  s_lshr_b32 s48, s48, 18
  s_mul_i32 s48, s48, 5
  s_sub_u32 s45, s45, s48
  s_cmp_eq_u32 s45, 2
  s_cselect_b64 vcc, -1, 0
  v_cndmask_b32 v251, v236, v237, vcc
  v_add_u32 v251, 4096, v251
  s_lshl_b32 s45, s44, 2
  s_add_u32 s45, s45, s20
  s_mul_i32 s45, s45, 74
  s_add_u32 s45, s45, s28
  s_lshl_b32 s95, s45, 10
  s_sub_u32 s45, s28, 54
  s_mul_i32 s45, s45, 40
  s_lshl_b32 s48, s72, 3
  s_add_u32 s45, s45, s48
  s_lshl_b32 s48, s28, 5
  s_cmp_ge_u32 s28, 54
  s_cselect_b32 s45, s45, s48
  s_sub_u32 s48, s28, 70
  s_mul_i32 s48, s48, 160
  s_mul_i32 s99, s20, 12
  s_add_u32 s48, s48, s99
  s_add_u32 s48, s48, 16
  s_lshl_b32 s99, s51, 4
  s_sub_u32 s48, s48, s99
  s_cmp_ge_u32 s28, 70
  s_cselect_b32 s45, s48, s45
  s_cselect_b32 s99, 97280, 0
  s_mul_i32 s45, s45, 1280
  s_lshl_b32 s44, s44, 7
  s_add_u32 s91, s45, s44
  s_cmp_ge_u32 s23, 740
  s_cselect_b32 s91, 1073741824, s91
  s_cselect_b32 s95, 1073741824, s95
  s_mul_i32 s23, s22, 3
  s_add_u32 s23, s23, 2
  s_mul_i32 s28, s23, 52429
  s_lshr_b32 s28, s28, 19
  s_mul_i32 s44, s28, 10
  s_sub_u32 s44, s23, s44
  s_lshl_b32 s45, s44, 1
  s_add_u32 s45, s45, s72
  s_mul_i32 s48, s45, 52429
  s_lshr_b32 s48, s48, 18
  s_mul_i32 s48, s48, 5
  s_sub_u32 s45, s45, s48
  s_cmp_eq_u32 s45, 2
  s_cselect_b64 vcc, -1, 0
  v_cndmask_b32 v252, v236, v237, vcc
  v_add_u32 v252, 8192, v252
  s_lshl_b32 s45, s44, 2
  s_add_u32 s45, s45, s20
  s_mul_i32 s45, s45, 74
  s_add_u32 s45, s45, s28
  s_lshl_b32 s96, s45, 10
  s_sub_u32 s45, s28, 54
  s_mul_i32 s45, s45, 40
  s_lshl_b32 s48, s72, 3
  s_add_u32 s45, s45, s48
  s_lshl_b32 s48, s28, 5
  s_cmp_ge_u32 s28, 54
  s_cselect_b32 s45, s45, s48
  s_sub_u32 s48, s28, 70
  s_mul_i32 s48, s48, 160
  s_mul_i32 s100, s20, 12
  s_add_u32 s48, s48, s100
  s_add_u32 s48, s48, 16
  s_lshl_b32 s100, s51, 4
  s_sub_u32 s48, s48, s100
  s_cmp_ge_u32 s28, 70
  s_cselect_b32 s45, s48, s45
  s_cselect_b32 s100, 97280, 0
  s_mul_i32 s45, s45, 1280
  s_lshl_b32 s44, s44, 7
  s_add_u32 s92, s45, s44
  s_cmp_ge_u32 s23, 740
  s_cselect_b32 s92, 1073741824, s92
  s_cselect_b32 s96, 1073741824, s96
  s_waitcnt vmcnt(21)
  v_lshlrev_b32 v144, 16, v222
  v_and_b32 v145, 0xffff0000, v222
  v_lshlrev_b32 v146, 16, v223
  v_and_b32 v147, 0xffff0000, v223
  s_waitcnt vmcnt(20)
  v_lshlrev_b32 v148, 16, v224
  v_and_b32 v149, 0xffff0000, v224
  v_lshlrev_b32 v150, 16, v225
  v_and_b32 v151, 0xffff0000, v225
  s_waitcnt vmcnt(19)
  v_lshlrev_b32 v152, 16, v226
  v_and_b32 v153, 0xffff0000, v226
  v_lshlrev_b32 v154, 16, v227
  v_and_b32 v155, 0xffff0000, v227
  s_waitcnt vmcnt(18)
  v_lshlrev_b32 v156, 16, v228
  v_and_b32 v157, 0xffff0000, v228
  v_lshlrev_b32 v158, 16, v229
  v_and_b32 v159, 0xffff0000, v229
  s_waitcnt vmcnt(17)
  v_lshlrev_b32 v160, 16, v230
  v_and_b32 v161, 0xffff0000, v230
  v_lshlrev_b32 v162, 16, v231
  v_and_b32 v163, 0xffff0000, v231
  v_mov_b32 v164, v144
  v_mov_b32 v165, v145
  v_mov_b32 v166, v146
  v_mov_b32 v167, v147
  v_add_f32 v164, v164, v148
  v_add_f32 v165, v165, v149
  v_add_f32 v166, v166, v150
  v_add_f32 v167, v167, v151
  v_add_f32 v164, v164, v152
  v_add_f32 v165, v165, v153
  v_add_f32 v166, v166, v154
  v_add_f32 v167, v167, v155
  v_add_f32 v164, v164, v156
  v_add_f32 v165, v165, v157
  v_add_f32 v166, v166, v158
  v_add_f32 v167, v167, v159
  v_add_f32 v164, v164, v160
  v_add_f32 v165, v165, v161
  v_add_f32 v166, v166, v162
  v_add_f32 v167, v167, v163
  v_add_f32 v164, v164, v165
  v_add_f32 v166, v166, v167
  v_add_f32 v232, v164, v166
  s_nop 1
  v_add_f32_dpp v232, v232, v232 row_ror:8 row_mask:0xf bank_mask:0xf
  s_nop 1
  v_add_f32_dpp v232, v232, v232 row_ror:4 row_mask:0xf bank_mask:0xf
  s_nop 1
  v_add_f32_dpp v232, v232, v232 row_ror:2 row_mask:0xf bank_mask:0xf
  s_nop 1
  v_add_f32_dpp v232, v232, v232 row_ror:1 row_mask:0xf bank_mask:0xf
  v_mov_b32 v233, v232
  s_nop 1
  v_permlane16_swap_b32 v232, v233
  v_add_f32 v232, v232, v233
  s_add_u32 m0, s26, 49152
  s_add_u32 s24, s24, s25
  buffer_load_dwordx4 v182, s[8:11], s24 offen offset:0  lds
  buffer_load_dwordx4 v183, s[8:11], s24 offen offset:1024  lds
  buffer_load_dwordx4 v184, s[8:11], s24 offen offset:2048  lds
  buffer_load_dwordx4 v185, s[8:11], s24 offen offset:3072  lds
  s_add_u32 m0, s27, 40960
  s_add_u32 s28, s52, 102400
  buffer_load_dwordx4 v186, s[4:7], s28 offen  lds
  v_mul_f32 v232, 0x3acccccd, v232
  v_sub_f32 v144, v144, v232
  v_sub_f32 v145, v145, v232
  v_sub_f32 v146, v146, v232
  v_sub_f32 v147, v147, v232
  v_sub_f32 v148, v148, v232
  v_sub_f32 v149, v149, v232
  v_sub_f32 v150, v150, v232
  v_sub_f32 v151, v151, v232
  v_sub_f32 v152, v152, v232
  v_sub_f32 v153, v153, v232
  v_sub_f32 v154, v154, v232
  v_sub_f32 v155, v155, v232
  v_sub_f32 v156, v156, v232
  v_sub_f32 v157, v157, v232
  v_sub_f32 v158, v158, v232
  v_sub_f32 v159, v159, v232
  v_sub_f32 v160, v160, v232
  v_sub_f32 v161, v161, v232
  v_sub_f32 v162, v162, v232
  v_sub_f32 v163, v163, v232
  v_mul_f32 v164, v144, v144
  v_mul_f32 v165, v145, v145
  v_mul_f32 v166, v146, v146
  v_mul_f32 v167, v147, v147
  v_fmac_f32 v164, v148, v148
  v_fmac_f32 v165, v149, v149
  v_fmac_f32 v166, v150, v150
  v_fmac_f32 v167, v151, v151
  v_fmac_f32 v164, v152, v152
  v_fmac_f32 v165, v153, v153
  v_fmac_f32 v166, v154, v154
  v_fmac_f32 v167, v155, v155
  v_fmac_f32 v164, v156, v156
  v_fmac_f32 v165, v157, v157
  v_fmac_f32 v166, v158, v158
  v_fmac_f32 v167, v159, v159
  v_fmac_f32 v164, v160, v160
  v_fmac_f32 v165, v161, v161
  v_fmac_f32 v166, v162, v162
  v_fmac_f32 v167, v163, v163
  v_add_f32 v164, v164, v165
  v_add_f32 v166, v166, v167
  v_add_f32 v234, v164, v166
  s_nop 1
  v_add_f32_dpp v234, v234, v234 row_ror:8 row_mask:0xf bank_mask:0xf
  s_nop 1
  v_add_f32_dpp v234, v234, v234 row_ror:4 row_mask:0xf bank_mask:0xf
  s_nop 1
  v_add_f32_dpp v234, v234, v234 row_ror:2 row_mask:0xf bank_mask:0xf
  s_nop 1
  v_add_f32_dpp v234, v234, v234 row_ror:1 row_mask:0xf bank_mask:0xf
  v_mov_b32 v233, v234
  s_nop 1
  v_permlane16_swap_b32 v234, v233
  v_add_f32 v234, v234, v233
  v_mul_f32 v234, 0x3acccccd, v234
  v_cvt_pk_bf16_f32 v235, v232, v234
  v_lshlrev_b32 v236, 16, v235
  v_and_b32 v234, 0xffff0000, v235
  v_add_f32 v234, 0x3727c5ac, v234
  v_cvt_pk_bf16_f32 v234, v234, v234
  v_and_b32 v234, 0xffff0000, v234
  v_sqrt_f32 v234, v234
  s_nop 0
  v_cvt_pk_bf16_f32 v234, v234, v234
  v_and_b32 v234, 0xffff0000, v234
  v_rcp_f32 v237, v234
  v_and_b32 v238, 31, v244
  v_cmp_eq_u32 vcc, 0, v238
  v_mov_b32 v239, 1073741824
  s_nop 0
  v_cndmask_b32 v238, v239, v242, vcc
  buffer_store_dwordx2 v[236:237], v238, s[12:15], s34 offen sc1
  s_waitcnt vmcnt(16)
  s_barrier
  ds_read_b64_tr_b16 a[0:1], v196 offset:0
  ds_read_b64_tr_b16 a[2:3], v196 offset:512
  ds_read_b64_tr_b16 a[4:5], v196 offset:8192
  ds_read_b64_tr_b16 a[6:7], v196 offset:8704
  ds_read_b64_tr_b16 a[8:9], v197 offset:0
  ds_read_b64_tr_b16 a[10:11], v197 offset:512
  ds_read_b64_tr_b16 a[12:13], v197 offset:8192
  ds_read_b64_tr_b16 a[14:15], v197 offset:8704
  ds_read_b128 a[176:179], v188 offset:16384
  ds_read_b128 a[180:183], v188 offset:8192
  s_waitcnt vmcnt(11)
  s_waitcnt lgkmcnt(2)
  s_barrier
  s_add_u32 m0, s26, 0
  s_waitcnt lgkmcnt(1)
  v_mfma_f32_16x16x32_bf16 v[32:35], a[0:3], a[176:179], 0
  ds_read_b128 v[176:179], v188 offset:0
  ds_read_b128 a[184:187], v188 offset:24576
  v_mfma_f32_16x16x32_bf16 v[36:39], a[4:7], a[176:179], 0
  s_mov_b32 s24, s58
  v_mfma_f32_16x16x32_bf16 v[40:43], a[8:11], a[176:179], 0
  buffer_load_dwordx4 v182, s[8:11], s24 offen offset:0  lds
  buffer_load_dwordx4 v183, s[8:11], s24 offen offset:1024  lds
  v_mfma_f32_16x16x32_bf16 v[44:47], a[12:15], a[176:179], 0
  buffer_load_dwordx4 v184, s[8:11], s24 offen offset:2048  lds
  s_waitcnt lgkmcnt(2)
  v_mfma_f32_16x16x32_bf16 v[16:19], a[0:3], a[180:183], 0
  ds_read_b128 a[188:191], v189 offset:16384
  buffer_load_dwordx4 v185, s[8:11], s24 offen offset:3072  lds
  v_mfma_f32_16x16x32_bf16 v[20:23], a[4:7], a[180:183], 0
  ds_read_b64_tr_b16 a[16:17], v196 offset:16384
  v_mfma_f32_16x16x32_bf16 v[24:27], a[8:11], a[180:183], 0
  ds_read_b64_tr_b16 a[18:19], v196 offset:16896
  ds_read_b64_tr_b16 a[20:21], v196 offset:24576
  v_mfma_f32_16x16x32_bf16 v[28:31], a[12:15], a[180:183], 0
  s_waitcnt lgkmcnt(5)
  v_cndmask_b32 v176, v176, v181, s[68:69]
  v_cndmask_b32 v177, v177, v181, s[68:69]
  v_cndmask_b32 v178, v178, v181, s[68:69]
  v_cndmask_b32 v179, v179, v181, s[68:69]
  s_add_u32 m0, s27, 4096
  s_nop 0
  buffer_load_dwordx4 v187, s[4:7], s53 offen  lds
  ds_read_b64_tr_b16 a[22:23], v196 offset:25088
  ds_read_b64_tr_b16 a[24:25], v197 offset:16384
  ds_read_b64_tr_b16 a[26:27], v197 offset:16896
  s_add_u32 m0, s27, 12288
  s_add_u32 s28, s53, 184320
  buffer_load_dwordx4 v186, s[4:7], s28 offen  lds
  ds_read_b64_tr_b16 a[28:29], v197 offset:24576
  ds_read_b64_tr_b16 a[30:31], v197 offset:25088
  s_add_u32 m0, s27, 20480
  s_add_u32 s28, s53, 163840
  buffer_load_dwordx4 v186, s[4:7], s28 offen  lds
  s_add_u32 m0, s27, 49152
  s_add_u32 s28, s52, 81920
  buffer_load_dwordx4 v186, s[4:7], s28 offen  lds
  v_mfma_f32_16x16x32_bf16 v[0:3], a[0:3], v[176:179], 0
  v_mfma_f32_16x16x32_bf16 v[4:7], a[4:7], v[176:179], 0
  v_mfma_f32_16x16x32_bf16 v[8:11], a[8:11], v[176:179], 0
  v_mfma_f32_16x16x32_bf16 v[12:15], a[12:15], v[176:179], 0
  s_waitcnt vmcnt(14)
  s_waitcnt lgkmcnt(0)
  s_barrier
  s_add_u32 m0, s26, 16384
  v_mfma_f32_16x16x32_bf16 v[48:51], a[0:3], a[184:187], 0
  ds_read_b128 v[176:179], v189 offset:0
  ds_read_b128 a[176:179], v189 offset:8192
  v_mfma_f32_16x16x32_bf16 v[52:55], a[4:7], a[184:187], 0
  s_add_u32 s24, s24, s25
  buffer_load_dwordx4 v182, s[8:11], s24 offen offset:0  lds
  v_mfma_f32_16x16x32_bf16 v[56:59], a[8:11], a[184:187], 0
  s_waitcnt lgkmcnt(1)
  v_cndmask_b32 v176, v176, v181, s[68:69]
  buffer_load_dwordx4 v183, s[8:11], s24 offen offset:1024  lds
  v_mfma_f32_16x16x32_bf16 v[60:63], a[12:15], a[184:187], 0
  buffer_load_dwordx4 v184, s[8:11], s24 offen offset:2048  lds
  v_mfma_f32_16x16x32_bf16 v[32:35], a[16:19], a[188:191], v[32:35]
  v_cndmask_b32 v177, v177, v181, s[68:69]
  ds_read_b128 a[180:183], v188 offset:32768
  v_mfma_f32_16x16x32_bf16 v[36:39], a[20:23], a[188:191], v[36:39]
  buffer_load_dwordx4 v185, s[8:11], s24 offen offset:3072  lds
  ds_read_b64_tr_b16 a[32:33], v196 offset:32768
  v_mfma_f32_16x16x32_bf16 v[40:43], a[24:27], a[188:191], v[40:43]
  v_cndmask_b32 v178, v178, v181, s[68:69]
  ds_read_b64_tr_b16 a[34:35], v196 offset:33280
  v_mfma_f32_16x16x32_bf16 v[44:47], a[28:31], a[188:191], v[44:47]
  ds_read_b64_tr_b16 a[36:37], v196 offset:40960
  s_waitcnt lgkmcnt(4)
  v_mfma_f32_16x16x32_bf16 v[16:19], a[16:19], a[176:179], v[16:19]
  v_cndmask_b32 v179, v179, v181, s[68:69]
  ds_read_b128 a[184:187], v189 offset:24576
  v_mfma_f32_16x16x32_bf16 v[20:23], a[20:23], a[176:179], v[20:23]
  s_add_u32 m0, s27, 28672
  v_mfma_f32_16x16x32_bf16 v[24:27], a[24:27], a[176:179], v[24:27]
  s_add_u32 s28, s53, 143360
  buffer_load_dwordx4 v186, s[4:7], s28 offen  lds
  v_mfma_f32_16x16x32_bf16 v[28:31], a[28:31], a[176:179], v[28:31]
  ds_read_b64_tr_b16 a[38:39], v196 offset:41472
  ds_read_b64_tr_b16 a[40:41], v197 offset:32768
  ds_read_b64_tr_b16 a[42:43], v197 offset:33280
  s_add_u32 m0, s27, 57344
  s_add_u32 s28, s52, 61440
  buffer_load_dwordx4 v186, s[4:7], s28 offen  lds
  ds_read_b64_tr_b16 a[44:45], v197 offset:40960
  ds_read_b64_tr_b16 a[46:47], v197 offset:41472
  v_mfma_f32_16x16x32_bf16 v[0:3], a[16:19], v[176:179], v[0:3]
  v_mfma_f32_16x16x32_bf16 v[4:7], a[20:23], v[176:179], v[4:7]
  v_mfma_f32_16x16x32_bf16 v[8:11], a[24:27], v[176:179], v[8:11]
  v_mfma_f32_16x16x32_bf16 v[12:15], a[28:31], v[176:179], v[12:15]
  s_waitcnt vmcnt(15)
  s_waitcnt lgkmcnt(0)
  s_barrier
  s_add_u32 m0, s26, 32768
  v_mfma_f32_16x16x32_bf16 v[64:67], a[0:3], a[180:183], 0
  ds_read_b128 v[176:179], v190 offset:0
  ds_read_b128 a[188:191], v190 offset:16384
  v_mfma_f32_16x16x32_bf16 v[68:71], a[4:7], a[180:183], 0
  s_add_u32 s24, s24, s25
  v_mfma_f32_16x16x32_bf16 v[72:75], a[8:11], a[180:183], 0
  buffer_load_dwordx4 v182, s[8:11], s24 offen offset:0  lds
  buffer_load_dwordx4 v183, s[8:11], s24 offen offset:1024  lds
  v_mfma_f32_16x16x32_bf16 v[76:79], a[12:15], a[180:183], 0
  buffer_load_dwordx4 v184, s[8:11], s24 offen offset:2048  lds
  v_mfma_f32_16x16x32_bf16 v[48:51], a[16:19], a[184:187], v[48:51]
  ds_read_b128 a[176:179], v190 offset:8192
  buffer_load_dwordx4 v185, s[8:11], s24 offen offset:3072  lds
  v_mfma_f32_16x16x32_bf16 v[52:55], a[20:23], a[184:187], v[52:55]
  ds_read_b64_tr_b16 a[48:49], v196 offset:49152
  ds_read_b64_tr_b16 a[50:51], v196 offset:49664
  v_mfma_f32_16x16x32_bf16 v[56:59], a[24:27], a[184:187], v[56:59]
  s_waitcnt lgkmcnt(4)
  v_cndmask_b32 v176, v176, v181, s[68:69]
  ds_read_b64_tr_b16 a[52:53], v196 offset:57344
  v_mfma_f32_16x16x32_bf16 v[60:63], a[28:31], a[184:187], v[60:63]
  s_add_u32 m0, s27, 36864
  s_waitcnt lgkmcnt(4)
  v_mfma_f32_16x16x32_bf16 v[32:35], a[32:35], a[188:191], v[32:35]
  v_cndmask_b32 v177, v177, v181, s[68:69]
  ds_read_b128 a[180:183], v188 offset:40960
  v_mfma_f32_16x16x32_bf16 v[36:39], a[36:39], a[188:191], v[36:39]
  s_add_u32 s28, s53, 122880
  buffer_load_dwordx4 v186, s[4:7], s28 offen  lds
  v_mfma_f32_16x16x32_bf16 v[40:43], a[40:43], a[188:191], v[40:43]
  v_cndmask_b32 v178, v178, v181, s[68:69]
  ds_read_b64_tr_b16 a[54:55], v196 offset:57856
  v_mfma_f32_16x16x32_bf16 v[44:47], a[44:47], a[188:191], v[44:47]
  ds_read_b64_tr_b16 a[56:57], v197 offset:49152
  s_waitcnt lgkmcnt(6)
  v_mfma_f32_16x16x32_bf16 v[16:19], a[32:35], a[176:179], v[16:19]
  v_cndmask_b32 v179, v179, v181, s[68:69]
  ds_read_b128 a[184:187], v189 offset:32768
  v_mfma_f32_16x16x32_bf16 v[20:23], a[36:39], a[176:179], v[20:23]
  ds_read_b64_tr_b16 a[58:59], v197 offset:49664
  v_mfma_f32_16x16x32_bf16 v[24:27], a[40:43], a[176:179], v[24:27]
  s_add_u32 m0, s27, 65536
  s_add_u32 s28, s52, 40960
  v_mfma_f32_16x16x32_bf16 v[28:31], a[44:47], a[176:179], v[28:31]
  buffer_load_dwordx4 v186, s[4:7], s28 offen  lds
  ds_read_b64_tr_b16 a[60:61], v197 offset:57344
  ds_read_b64_tr_b16 a[62:63], v197 offset:57856
  v_mfma_f32_16x16x32_bf16 v[0:3], a[32:35], v[176:179], v[0:3]
  v_mfma_f32_16x16x32_bf16 v[4:7], a[36:39], v[176:179], v[4:7]
  v_mfma_f32_16x16x32_bf16 v[8:11], a[40:43], v[176:179], v[8:11]
  v_mfma_f32_16x16x32_bf16 v[12:15], a[44:47], v[176:179], v[12:15]
  s_waitcnt vmcnt(12)
  s_waitcnt lgkmcnt(0)
  s_barrier
  s_lshr_b32 s22, s2, 2
  s_lshl_b32 s22, s22, 2
  s_cmp_eq_u32 s20, 0
  s_cselect_b32 s22, s22, 1073741824
  v_mov_b32 v232, s22
  v_mov_b32 v233, 1073741824
  v_cmp_eq_u32 vcc, 0, v244
  s_nop 1
  v_cndmask_b32 v232, v233, v232, vcc
  v_mov_b32 v233, 1
  buffer_atomic_add v233, v232, s[16:19], 0 offen sc1
  s_add_u32 m0, s26, 49152
  v_mfma_f32_16x16x32_bf16 v[80:83], a[0:3], a[180:183], 0
  ds_read_b128 v[176:179], v191 offset:0
  ds_read_b128 a[188:191], v190 offset:24576
  v_mfma_f32_16x16x32_bf16 v[84:87], a[4:7], a[180:183], 0
  s_add_u32 s24, s24, s25
  v_mfma_f32_16x16x32_bf16 v[88:91], a[8:11], a[180:183], 0
  buffer_load_dwordx4 v182, s[8:11], s24 offen offset:0  lds
  buffer_load_dwordx4 v183, s[8:11], s24 offen offset:1024  lds
  v_mfma_f32_16x16x32_bf16 v[92:95], a[12:15], a[180:183], 0
  buffer_load_dwordx4 v184, s[8:11], s24 offen offset:2048  lds
  v_mfma_f32_16x16x32_bf16 v[64:67], a[16:19], a[184:187], v[64:67]
  ds_read_b128 a[176:179], v191 offset:16384
  v_mfma_f32_16x16x32_bf16 v[68:71], a[20:23], a[184:187], v[68:71]
  buffer_load_dwordx4 v185, s[8:11], s24 offen offset:3072  lds
  v_mfma_f32_16x16x32_bf16 v[72:75], a[24:27], a[184:187], v[72:75]
  ds_read_b64_tr_b16 a[64:65], v196 offset:0
  ds_read_b64_tr_b16 a[66:67], v196 offset:512
  v_mfma_f32_16x16x32_bf16 v[76:79], a[28:31], a[184:187], v[76:79]
  ds_read_b64_tr_b16 a[68:69], v196 offset:8192
  s_waitcnt lgkmcnt(4)
  v_mfma_f32_16x16x32_bf16 v[48:51], a[32:35], a[188:191], v[48:51]
  ds_read_b128 a[180:183], v191 offset:8192
  v_mfma_f32_16x16x32_bf16 v[52:55], a[36:39], a[188:191], v[52:55]
  s_add_u32 m0, s27, 45056
  s_add_u32 s28, s53, 102400
  v_mfma_f32_16x16x32_bf16 v[56:59], a[40:43], a[188:191], v[56:59]
  v_cndmask_b32 v176, v176, v181, s[68:69]
  buffer_load_dwordx4 v186, s[4:7], s28 offen  lds
  v_mfma_f32_16x16x32_bf16 v[60:63], a[44:47], a[188:191], v[60:63]
  ds_read_b64_tr_b16 a[70:71], v196 offset:8704
  s_waitcnt lgkmcnt(5)
  v_mfma_f32_16x16x32_bf16 v[32:35], a[48:51], a[176:179], v[32:35]
  v_cndmask_b32 v177, v177, v181, s[68:69]
  ds_read_b128 a[184:187], v192 offset:4096
  v_mfma_f32_16x16x32_bf16 v[36:39], a[52:55], a[176:179], v[36:39]
  ds_read_b64_tr_b16 a[72:73], v197 offset:0
  ds_read_b64_tr_b16 a[74:75], v197 offset:512
  v_mfma_f32_16x16x32_bf16 v[40:43], a[56:59], a[176:179], v[40:43]
  v_cndmask_b32 v178, v178, v181, s[68:69]
  s_add_u32 m0, s27, 73728
  v_mfma_f32_16x16x32_bf16 v[44:47], a[60:63], a[176:179], v[44:47]
  s_add_u32 s28, s52, 20480
  s_waitcnt lgkmcnt(4)
  v_mfma_f32_16x16x32_bf16 v[16:19], a[48:51], a[180:183], v[16:19]
  v_cndmask_b32 v179, v179, v181, s[68:69]
  ds_read_b128 a[188:191], v189 offset:40960
  v_mfma_f32_16x16x32_bf16 v[20:23], a[52:55], a[180:183], v[20:23]
  buffer_load_dwordx4 v186, s[4:7], s28 offen  lds
  v_mfma_f32_16x16x32_bf16 v[24:27], a[56:59], a[180:183], v[24:27]
  ds_read_b64_tr_b16 a[76:77], v197 offset:8192
  ds_read_b64_tr_b16 a[78:79], v197 offset:8704
  v_mfma_f32_16x16x32_bf16 v[28:31], a[60:63], a[180:183], v[28:31]
  v_mfma_f32_16x16x32_bf16 v[0:3], a[48:51], v[176:179], v[0:3]
  v_mfma_f32_16x16x32_bf16 v[4:7], a[52:55], v[176:179], v[4:7]
  v_mfma_f32_16x16x32_bf16 v[8:11], a[56:59], v[176:179], v[8:11]
  v_mfma_f32_16x16x32_bf16 v[12:15], a[60:63], v[176:179], v[12:15]
  s_waitcnt vmcnt(13)
  s_waitcnt lgkmcnt(0)
  s_barrier
  s_add_u32 m0, s26, 0
  v_mfma_f32_16x16x32_bf16 v[96:99], a[0:3], a[184:187], 0
  ds_read_b128 v[176:179], v188 offset:4096
  ds_read_b128 a[176:179], v190 offset:32768
  v_mfma_f32_16x16x32_bf16 v[100:103], a[4:7], a[184:187], 0
  s_mov_b32 s24, s59
  v_mfma_f32_16x16x32_bf16 v[104:107], a[8:11], a[184:187], 0
  buffer_load_dwordx4 v182, s[8:11], s24 offen offset:0  lds
  buffer_load_dwordx4 v183, s[8:11], s24 offen offset:1024  lds
  v_mfma_f32_16x16x32_bf16 v[108:111], a[12:15], a[184:187], 0
  buffer_load_dwordx4 v184, s[8:11], s24 offen offset:2048  lds
  v_mfma_f32_16x16x32_bf16 v[80:83], a[16:19], a[188:191], v[80:83]
  ds_read_b128 a[180:183], v191 offset:24576
  buffer_load_dwordx4 v185, s[8:11], s24 offen offset:3072  lds
  v_mfma_f32_16x16x32_bf16 v[84:87], a[20:23], a[188:191], v[84:87]
  ds_read_b64_tr_b16 a[80:81], v196 offset:16384
  v_mfma_f32_16x16x32_bf16 v[88:91], a[24:27], a[188:191], v[88:91]
  ds_read_b64_tr_b16 a[82:83], v196 offset:16896
  ds_read_b64_tr_b16 a[84:85], v196 offset:24576
  v_mfma_f32_16x16x32_bf16 v[92:95], a[28:31], a[188:191], v[92:95]
  s_add_u32 m0, s27, 0
  s_waitcnt lgkmcnt(4)
  v_mfma_f32_16x16x32_bf16 v[64:67], a[32:35], a[176:179], v[64:67]
  ds_read_b128 a[184:187], v188 offset:20480
  buffer_load_dwordx4 v187, s[4:7], s54 offen  lds
  v_mfma_f32_16x16x32_bf16 v[68:71], a[36:39], a[176:179], v[68:71]
  ds_read_b64_tr_b16 a[86:87], v196 offset:25088
  v_mfma_f32_16x16x32_bf16 v[72:75], a[40:43], a[176:179], v[72:75]
  ds_read_b64_tr_b16 a[88:89], v197 offset:16384
  ds_read_b64_tr_b16 a[90:91], v197 offset:16896
  v_mfma_f32_16x16x32_bf16 v[76:79], a[44:47], a[176:179], v[76:79]
  s_add_u32 m0, s27, 8192
  s_waitcnt lgkmcnt(7)
  v_mfma_f32_16x16x32_bf16 v[48:51], a[48:51], a[180:183], v[48:51]
  ds_read_b128 a[188:191], v188 offset:12288
  v_mfma_f32_16x16x32_bf16 v[52:55], a[52:55], a[180:183], v[52:55]
  s_add_u32 s28, s54, 184320
  buffer_load_dwordx4 v186, s[4:7], s28 offen  lds
  v_mfma_f32_16x16x32_bf16 v[56:59], a[56:59], a[180:183], v[56:59]
  v_cndmask_b32 v176, v176, v181, s[68:69]
  ds_read_b64_tr_b16 a[92:93], v197 offset:24576
  v_mfma_f32_16x16x32_bf16 v[60:63], a[60:63], a[180:183], v[60:63]
  ds_read_b64_tr_b16 a[94:95], v197 offset:25088
  s_waitcnt lgkmcnt(6)
  v_mfma_f32_16x16x32_bf16 v[32:35], a[64:67], a[184:187], v[32:35]
  v_cndmask_b32 v177, v177, v181, s[68:69]
  ds_read_b128 a[176:179], v192 offset:12288
  v_mfma_f32_16x16x32_bf16 v[36:39], a[68:71], a[184:187], v[36:39]
  s_add_u32 m0, s27, 16384
  s_add_u32 s28, s54, 163840
  v_mfma_f32_16x16x32_bf16 v[40:43], a[72:75], a[184:187], v[40:43]
  v_cndmask_b32 v178, v178, v181, s[68:69]
  buffer_load_dwordx4 v186, s[4:7], s28 offen  lds
  v_mfma_f32_16x16x32_bf16 v[44:47], a[76:79], a[184:187], v[44:47]
  s_add_u32 m0, s27, 53248
  s_waitcnt lgkmcnt(3)
  v_mfma_f32_16x16x32_bf16 v[16:19], a[64:67], a[188:191], v[16:19]
  v_cndmask_b32 v179, v179, v181, s[68:69]
  ds_read_b128 a[180:183], v193 offset:4096
  v_mfma_f32_16x16x32_bf16 v[20:23], a[68:71], a[188:191], v[20:23]
  s_add_u32 s28, s53, 81920
  v_mfma_f32_16x16x32_bf16 v[24:27], a[72:75], a[188:191], v[24:27]
  buffer_load_dwordx4 v186, s[4:7], s28 offen  lds
  s_add_u32 m0, s27, 81920
  v_mfma_f32_16x16x32_bf16 v[28:31], a[76:79], a[188:191], v[28:31]
  s_add_u32 s28, s52, 0
  buffer_load_dwordx4 v186, s[4:7], s28 offen  lds
  v_mfma_f32_16x16x32_bf16 v[0:3], a[64:67], v[176:179], v[0:3]
  v_mfma_f32_16x16x32_bf16 v[4:7], a[68:71], v[176:179], v[4:7]
  v_mfma_f32_16x16x32_bf16 v[8:11], a[72:75], v[176:179], v[8:11]
  v_mfma_f32_16x16x32_bf16 v[12:15], a[76:79], v[176:179], v[12:15]
  s_waitcnt vmcnt(16)
  s_waitcnt lgkmcnt(2)
  s_barrier
  s_add_u32 m0, s26, 16384
  s_waitcnt lgkmcnt(1)
  v_mfma_f32_16x16x32_bf16 v[112:115], a[0:3], a[176:179], 0
  ds_read_b128 v[176:179], v189 offset:4096
  ds_read_b128 a[184:187], v190 offset:40960
  v_mfma_f32_16x16x32_bf16 v[116:119], a[4:7], a[176:179], 0
  s_add_u32 s24, s24, s25
  v_mfma_f32_16x16x32_bf16 v[120:123], a[8:11], a[176:179], 0
  buffer_load_dwordx4 v182, s[8:11], s24 offen offset:0  lds
  v_mfma_f32_16x16x32_bf16 v[124:127], a[12:15], a[176:179], 0
  buffer_load_dwordx4 v183, s[8:11], s24 offen offset:1024  lds
  s_waitcnt lgkmcnt(2)
  v_mfma_f32_16x16x32_bf16 v[96:99], a[16:19], a[180:183], v[96:99]
  ds_read_b128 a[188:191], v191 offset:32768
  v_mfma_f32_16x16x32_bf16 v[100:103], a[20:23], a[180:183], v[100:103]
  buffer_load_dwordx4 v184, s[8:11], s24 offen offset:2048  lds
  v_mfma_f32_16x16x32_bf16 v[104:107], a[24:27], a[180:183], v[104:107]
  buffer_load_dwordx4 v185, s[8:11], s24 offen offset:3072  lds
  v_mfma_f32_16x16x32_bf16 v[108:111], a[28:31], a[180:183], v[108:111]
  ds_read_b64_tr_b16 a[96:97], v196 offset:32768
  s_waitcnt lgkmcnt(2)
  v_mfma_f32_16x16x32_bf16 v[80:83], a[32:35], a[184:187], v[80:83]
  ds_read_b128 a[176:179], v188 offset:28672
  v_mfma_f32_16x16x32_bf16 v[84:87], a[36:39], a[184:187], v[84:87]
  ds_read_b64_tr_b16 a[98:99], v196 offset:33280
  v_mfma_f32_16x16x32_bf16 v[88:91], a[40:43], a[184:187], v[88:91]
  ds_read_b64_tr_b16 a[100:101], v196 offset:40960
  v_mfma_f32_16x16x32_bf16 v[92:95], a[44:47], a[184:187], v[92:95]
  s_waitcnt lgkmcnt(4)
  v_mfma_f32_16x16x32_bf16 v[64:67], a[48:51], a[188:191], v[64:67]
  ds_read_b128 a[180:183], v189 offset:20480
  v_mfma_f32_16x16x32_bf16 v[68:71], a[52:55], a[188:191], v[68:71]
  s_add_u32 m0, s27, 24576
  v_mfma_f32_16x16x32_bf16 v[72:75], a[56:59], a[188:191], v[72:75]
  s_add_u32 s28, s54, 143360
  buffer_load_dwordx4 v186, s[4:7], s28 offen  lds
  v_mfma_f32_16x16x32_bf16 v[76:79], a[60:63], a[188:191], v[76:79]
  s_waitcnt lgkmcnt(3)
  v_mfma_f32_16x16x32_bf16 v[48:51], a[64:67], a[176:179], v[48:51]
  ds_read_b128 a[184:187], v189 offset:12288
  v_mfma_f32_16x16x32_bf16 v[52:55], a[68:71], a[176:179], v[52:55]
  ds_read_b64_tr_b16 a[102:103], v196 offset:41472
  ds_read_b64_tr_b16 a[104:105], v197 offset:32768
  v_mfma_f32_16x16x32_bf16 v[56:59], a[72:75], a[176:179], v[56:59]
  v_cndmask_b32 v176, v176, v181, s[68:69]
  v_mfma_f32_16x16x32_bf16 v[60:63], a[76:79], a[176:179], v[60:63]
  ds_read_b64_tr_b16 a[106:107], v197 offset:33280
  s_waitcnt lgkmcnt(4)
  v_mfma_f32_16x16x32_bf16 v[32:35], a[80:83], a[180:183], v[32:35]
  v_cndmask_b32 v177, v177, v181, s[68:69]
  ds_read_b128 a[188:191], v192 offset:20480
  v_mfma_f32_16x16x32_bf16 v[36:39], a[84:87], a[180:183], v[36:39]
  s_add_u32 m0, s27, 61440
  v_mfma_f32_16x16x32_bf16 v[40:43], a[88:91], a[180:183], v[40:43]
  v_cndmask_b32 v178, v178, v181, s[68:69]
  s_add_u32 s28, s53, 61440
  v_mfma_f32_16x16x32_bf16 v[44:47], a[92:95], a[180:183], v[44:47]
  buffer_load_dwordx4 v186, s[4:7], s28 offen  lds
  s_waitcnt lgkmcnt(4)
  v_mfma_f32_16x16x32_bf16 v[16:19], a[80:83], a[184:187], v[16:19]
  v_cndmask_b32 v179, v179, v181, s[68:69]
  ds_read_b128 a[176:179], v193 offset:12288
  v_mfma_f32_16x16x32_bf16 v[20:23], a[84:87], a[184:187], v[20:23]
  ds_read_b64_tr_b16 a[108:109], v197 offset:40960
  v_mfma_f32_16x16x32_bf16 v[24:27], a[88:91], a[184:187], v[24:27]
  ds_read_b64_tr_b16 a[110:111], v197 offset:41472
  v_mfma_f32_16x16x32_bf16 v[28:31], a[92:95], a[184:187], v[28:31]
  v_mfma_f32_16x16x32_bf16 v[0:3], a[80:83], v[176:179], v[0:3]
  v_mfma_f32_16x16x32_bf16 v[4:7], a[84:87], v[176:179], v[4:7]
  v_mfma_f32_16x16x32_bf16 v[8:11], a[88:91], v[176:179], v[8:11]
  v_mfma_f32_16x16x32_bf16 v[12:15], a[92:95], v[176:179], v[12:15]
  s_waitcnt vmcnt(15)
  s_waitcnt lgkmcnt(0)
  s_barrier
  s_add_u32 m0, s26, 32768
  v_mfma_f32_16x16x32_bf16 v[128:131], a[0:3], a[188:191], 0
  ds_read_b128 v[176:179], v190 offset:4096
  ds_read_b128 a[180:183], v194 offset:4096
  v_mfma_f32_16x16x32_bf16 v[132:135], a[4:7], a[188:191], 0
  s_add_u32 s24, s24, s25
  v_mfma_f32_16x16x32_bf16 v[136:139], a[8:11], a[188:191], 0
  buffer_load_dwordx4 v182, s[8:11], s24 offen offset:0  lds
  v_mfma_f32_16x16x32_bf16 v[140:143], a[12:15], a[188:191], 0
  buffer_load_dwordx4 v183, s[8:11], s24 offen offset:1024  lds
  v_mfma_f32_16x16x32_bf16 v[112:115], a[16:19], a[176:179], v[112:115]
  ds_read_b128 a[184:187], v191 offset:40960
  v_mfma_f32_16x16x32_bf16 v[116:119], a[20:23], a[176:179], v[116:119]
  buffer_load_dwordx4 v184, s[8:11], s24 offen offset:2048  lds
  v_mfma_f32_16x16x32_bf16 v[120:123], a[24:27], a[176:179], v[120:123]
  v_mfma_f32_16x16x32_bf16 v[124:127], a[28:31], a[176:179], v[124:127]
  buffer_load_dwordx4 v185, s[8:11], s24 offen offset:3072  lds
  s_waitcnt lgkmcnt(1)
  v_mfma_f32_16x16x32_bf16 v[96:99], a[32:35], a[180:183], v[96:99]
  ds_read_b128 a[188:191], v188 offset:36864
  v_mfma_f32_16x16x32_bf16 v[100:103], a[36:39], a[180:183], v[100:103]
  ds_read_b64_tr_b16 a[112:113], v196 offset:49152
  v_mfma_f32_16x16x32_bf16 v[104:107], a[40:43], a[180:183], v[104:107]
  ds_read_b64_tr_b16 a[114:115], v196 offset:49664
  v_mfma_f32_16x16x32_bf16 v[108:111], a[44:47], a[180:183], v[108:111]
  s_waitcnt lgkmcnt(3)
  v_mfma_f32_16x16x32_bf16 v[80:83], a[48:51], a[184:187], v[80:83]
  ds_read_b128 a[176:179], v189 offset:28672
  v_mfma_f32_16x16x32_bf16 v[84:87], a[52:55], a[184:187], v[84:87]
  ds_read_b64_tr_b16 a[116:117], v196 offset:57344
  v_mfma_f32_16x16x32_bf16 v[88:91], a[56:59], a[184:187], v[88:91]
  s_add_u32 m0, s27, 32768
  v_mfma_f32_16x16x32_bf16 v[92:95], a[60:63], a[184:187], v[92:95]
  s_add_u32 s28, s54, 122880
  s_waitcnt lgkmcnt(4)
  v_mfma_f32_16x16x32_bf16 v[64:67], a[64:67], a[188:191], v[64:67]
  ds_read_b128 a[180:183], v190 offset:20480
  v_mfma_f32_16x16x32_bf16 v[68:71], a[68:71], a[188:191], v[68:71]
  buffer_load_dwordx4 v186, s[4:7], s28 offen  lds
  v_mfma_f32_16x16x32_bf16 v[72:75], a[72:75], a[188:191], v[72:75]
  ds_read_b64_tr_b16 a[118:119], v196 offset:57856
  v_mfma_f32_16x16x32_bf16 v[76:79], a[76:79], a[188:191], v[76:79]
  s_waitcnt lgkmcnt(3)
  v_mfma_f32_16x16x32_bf16 v[48:51], a[80:83], a[176:179], v[48:51]
  ds_read_b128 a[184:187], v190 offset:12288
  v_mfma_f32_16x16x32_bf16 v[52:55], a[84:87], a[176:179], v[52:55]
  ds_read_b64_tr_b16 a[120:121], v197 offset:49152
  v_mfma_f32_16x16x32_bf16 v[56:59], a[88:91], a[176:179], v[56:59]
  v_cndmask_b32 v176, v176, v181, s[68:69]
  ds_read_b64_tr_b16 a[122:123], v197 offset:49664
  v_mfma_f32_16x16x32_bf16 v[60:63], a[92:95], a[176:179], v[60:63]
  s_add_u32 m0, s27, 69632
  s_waitcnt lgkmcnt(4)
  v_mfma_f32_16x16x32_bf16 v[32:35], a[96:99], a[180:183], v[32:35]
  v_cndmask_b32 v177, v177, v181, s[68:69]
  ds_read_b128 a[188:191], v192 offset:28672
  v_mfma_f32_16x16x32_bf16 v[36:39], a[100:103], a[180:183], v[36:39]
  s_add_u32 s28, s53, 40960
  v_mfma_f32_16x16x32_bf16 v[40:43], a[104:107], a[180:183], v[40:43]
  v_cndmask_b32 v178, v178, v181, s[68:69]
  v_mfma_f32_16x16x32_bf16 v[44:47], a[108:111], a[180:183], v[44:47]
  buffer_load_dwordx4 v186, s[4:7], s28 offen  lds
  s_waitcnt lgkmcnt(3)
  v_mfma_f32_16x16x32_bf16 v[16:19], a[96:99], a[184:187], v[16:19]
  v_cndmask_b32 v179, v179, v181, s[68:69]
  ds_read_b128 a[176:179], v193 offset:20480
  v_mfma_f32_16x16x32_bf16 v[20:23], a[100:103], a[184:187], v[20:23]
  ds_read_b64_tr_b16 a[124:125], v197 offset:57344
  v_mfma_f32_16x16x32_bf16 v[24:27], a[104:107], a[184:187], v[24:27]
  ds_read_b64_tr_b16 a[126:127], v197 offset:57856
  v_mfma_f32_16x16x32_bf16 v[28:31], a[108:111], a[184:187], v[28:31]
  v_mfma_f32_16x16x32_bf16 v[0:3], a[96:99], v[176:179], v[0:3]
  v_mfma_f32_16x16x32_bf16 v[4:7], a[100:103], v[176:179], v[4:7]
  v_mfma_f32_16x16x32_bf16 v[8:11], a[104:107], v[176:179], v[8:11]
  v_mfma_f32_16x16x32_bf16 v[12:15], a[108:111], v[176:179], v[12:15]
  s_waitcnt vmcnt(12)
  s_waitcnt lgkmcnt(0)
  s_barrier
  s_add_u32 m0, s26, 49152
  v_mfma_f32_16x16x32_bf16 v[144:147], a[0:3], a[188:191], 0
  ds_read_b128 v[176:179], v191 offset:4096
  ds_read_b128 a[180:183], v194 offset:12288
  v_mfma_f32_16x16x32_bf16 v[148:151], a[4:7], a[188:191], 0
  s_add_u32 s24, s24, s25
  v_mfma_f32_16x16x32_bf16 v[152:155], a[8:11], a[188:191], 0
  buffer_load_dwordx4 v182, s[8:11], s24 offen offset:0  lds
  v_mfma_f32_16x16x32_bf16 v[156:159], a[12:15], a[188:191], 0
  v_mfma_f32_16x16x32_bf16 v[128:131], a[16:19], a[176:179], v[128:131]
  ds_read_b128 a[184:187], v195 offset:4096
  v_mfma_f32_16x16x32_bf16 v[132:135], a[20:23], a[176:179], v[132:135]
  buffer_load_dwordx4 v183, s[8:11], s24 offen offset:1024  lds
  v_mfma_f32_16x16x32_bf16 v[136:139], a[24:27], a[176:179], v[136:139]
  buffer_load_dwordx4 v184, s[8:11], s24 offen offset:2048  lds
  v_mfma_f32_16x16x32_bf16 v[140:143], a[28:31], a[176:179], v[140:143]
  s_waitcnt lgkmcnt(1)
  v_mfma_f32_16x16x32_bf16 v[112:115], a[32:35], a[180:183], v[112:115]
  ds_read_b128 a[188:191], v192 offset:0
  v_mfma_f32_16x16x32_bf16 v[116:119], a[36:39], a[180:183], v[116:119]
  buffer_load_dwordx4 v185, s[8:11], s24 offen offset:3072  lds
  v_mfma_f32_16x16x32_bf16 v[120:123], a[40:43], a[180:183], v[120:123]
  ds_read_b64_tr_b16 a[128:129], v196 offset:0
  v_mfma_f32_16x16x32_bf16 v[124:127], a[44:47], a[180:183], v[124:127]
  ds_read_b64_tr_b16 a[130:131], v196 offset:512
  s_waitcnt lgkmcnt(3)
  v_mfma_f32_16x16x32_bf16 v[96:99], a[48:51], a[184:187], v[96:99]
  ds_read_b128 a[176:179], v189 offset:36864
  v_mfma_f32_16x16x32_bf16 v[100:103], a[52:55], a[184:187], v[100:103]
  ds_read_b64_tr_b16 a[132:133], v196 offset:8192
  v_mfma_f32_16x16x32_bf16 v[104:107], a[56:59], a[184:187], v[104:107]
  v_mfma_f32_16x16x32_bf16 v[108:111], a[60:63], a[184:187], v[108:111]
  s_add_u32 m0, s27, 40960
  s_waitcnt lgkmcnt(4)
  v_mfma_f32_16x16x32_bf16 v[80:83], a[64:67], a[188:191], v[80:83]
  ds_read_b128 a[180:183], v190 offset:28672
  v_mfma_f32_16x16x32_bf16 v[84:87], a[68:71], a[188:191], v[84:87]
  s_add_u32 s28, s54, 102400
  v_mfma_f32_16x16x32_bf16 v[88:91], a[72:75], a[188:191], v[88:91]
  v_mfma_f32_16x16x32_bf16 v[92:95], a[76:79], a[188:191], v[92:95]
  buffer_load_dwordx4 v186, s[4:7], s28 offen  lds
  s_waitcnt lgkmcnt(2)
  v_mfma_f32_16x16x32_bf16 v[64:67], a[80:83], a[176:179], v[64:67]
  ds_read_b128 a[184:187], v191 offset:20480
  v_mfma_f32_16x16x32_bf16 v[68:71], a[84:87], a[176:179], v[68:71]
  ds_read_b64_tr_b16 a[134:135], v196 offset:8704
  v_mfma_f32_16x16x32_bf16 v[72:75], a[88:91], a[176:179], v[72:75]
  v_mfma_f32_16x16x32_bf16 v[76:79], a[92:95], a[176:179], v[76:79]
  ds_read_b64_tr_b16 a[136:137], v197 offset:0
  s_waitcnt lgkmcnt(3)
  v_mfma_f32_16x16x32_bf16 v[48:51], a[96:99], a[180:183], v[48:51]
  ds_read_b128 a[188:191], v191 offset:12288
  v_mfma_f32_16x16x32_bf16 v[52:55], a[100:103], a[180:183], v[52:55]
  ds_read_b64_tr_b16 a[138:139], v197 offset:512
  v_mfma_f32_16x16x32_bf16 v[56:59], a[104:107], a[180:183], v[56:59]
  v_cndmask_b32 v176, v176, v181, s[68:69]
  s_add_u32 m0, s27, 77824
  v_mfma_f32_16x16x32_bf16 v[60:63], a[108:111], a[180:183], v[60:63]
  s_waitcnt lgkmcnt(4)
  v_mfma_f32_16x16x32_bf16 v[32:35], a[112:115], a[184:187], v[32:35]
  v_cndmask_b32 v177, v177, v181, s[68:69]
  ds_read_b128 a[176:179], v192 offset:36864
  v_mfma_f32_16x16x32_bf16 v[36:39], a[116:119], a[184:187], v[36:39]
  s_add_u32 s28, s53, 20480
  v_mfma_f32_16x16x32_bf16 v[40:43], a[120:123], a[184:187], v[40:43]
  v_cndmask_b32 v178, v178, v181, s[68:69]
  buffer_load_dwordx4 v186, s[4:7], s28 offen  lds
  v_mfma_f32_16x16x32_bf16 v[44:47], a[124:127], a[184:187], v[44:47]
  s_waitcnt lgkmcnt(2)
  v_mfma_f32_16x16x32_bf16 v[16:19], a[112:115], a[188:191], v[16:19]
  v_cndmask_b32 v179, v179, v181, s[68:69]
  ds_read_b128 a[180:183], v193 offset:28672
  v_mfma_f32_16x16x32_bf16 v[20:23], a[116:119], a[188:191], v[20:23]
  ds_read_b64_tr_b16 a[140:141], v197 offset:8192
  v_mfma_f32_16x16x32_bf16 v[24:27], a[120:123], a[188:191], v[24:27]
  ds_read_b64_tr_b16 a[142:143], v197 offset:8704
  v_mfma_f32_16x16x32_bf16 v[28:31], a[124:127], a[188:191], v[28:31]
  v_mfma_f32_16x16x32_bf16 v[0:3], a[112:115], v[176:179], v[0:3]
  v_mfma_f32_16x16x32_bf16 v[4:7], a[116:119], v[176:179], v[4:7]
  v_mfma_f32_16x16x32_bf16 v[8:11], a[120:123], v[176:179], v[8:11]
  v_mfma_f32_16x16x32_bf16 v[12:15], a[124:127], v[176:179], v[12:15]
  s_waitcnt vmcnt(12)
  s_waitcnt lgkmcnt(0)
  s_barrier
  s_add_u32 m0, s26, 0
  v_mfma_f32_16x16x32_bf16 v[160:163], a[0:3], a[176:179], 0
  ds_read_b128 v[176:179], v188 offset:0
  ds_read_b128 a[184:187], v194 offset:20480
  v_mfma_f32_16x16x32_bf16 v[164:167], a[4:7], a[176:179], 0
  s_mov_b32 s24, s60
  v_mfma_f32_16x16x32_bf16 v[168:171], a[8:11], a[176:179], 0
  buffer_load_dwordx4 v182, s[8:11], s24 offen offset:0  lds
  v_mfma_f32_16x16x32_bf16 v[172:175], a[12:15], a[176:179], 0
  buffer_load_dwordx4 v183, s[8:11], s24 offen offset:1024  lds
  v_mfma_f32_16x16x32_bf16 v[144:147], a[16:19], a[180:183], v[144:147]
  ds_read_b128 a[188:191], v195 offset:12288
  v_mfma_f32_16x16x32_bf16 v[148:151], a[20:23], a[180:183], v[148:151]
  buffer_load_dwordx4 v184, s[8:11], s24 offen offset:2048  lds
  v_mfma_f32_16x16x32_bf16 v[152:155], a[24:27], a[180:183], v[152:155]
  buffer_load_dwordx4 v185, s[8:11], s24 offen offset:3072  lds
  v_mfma_f32_16x16x32_bf16 v[156:159], a[28:31], a[180:183], v[156:159]
  ds_read_b64_tr_b16 a[0:1], v196 offset:16384
  s_waitcnt lgkmcnt(2)
  v_mfma_f32_16x16x32_bf16 v[128:131], a[32:35], a[184:187], v[128:131]
  ds_read_b128 a[176:179], v192 offset:8192
  v_mfma_f32_16x16x32_bf16 v[132:135], a[36:39], a[184:187], v[132:135]
  ds_read_b64_tr_b16 a[2:3], v196 offset:16896
  v_mfma_f32_16x16x32_bf16 v[136:139], a[40:43], a[184:187], v[136:139]
  ds_read_b64_tr_b16 a[4:5], v196 offset:24576
  v_mfma_f32_16x16x32_bf16 v[140:143], a[44:47], a[184:187], v[140:143]
  s_waitcnt lgkmcnt(4)
  v_mfma_f32_16x16x32_bf16 v[112:115], a[48:51], a[188:191], v[112:115]
  ds_read_b128 a[180:183], v193 offset:0
  v_mfma_f32_16x16x32_bf16 v[116:119], a[52:55], a[188:191], v[116:119]
  s_add_u32 m0, s27, 4096
  v_mfma_f32_16x16x32_bf16 v[120:123], a[56:59], a[188:191], v[120:123]
  buffer_load_dwordx4 v187, s[4:7], s55 offen  lds
  v_mfma_f32_16x16x32_bf16 v[124:127], a[60:63], a[188:191], v[124:127]
  ds_read_b64_tr_b16 a[6:7], v196 offset:25088
  s_waitcnt lgkmcnt(4)
  v_mfma_f32_16x16x32_bf16 v[96:99], a[64:67], a[176:179], v[96:99]
  ds_read_b128 a[184:187], v190 offset:36864
  v_mfma_f32_16x16x32_bf16 v[100:103], a[68:71], a[176:179], v[100:103]
  ds_read_b64_tr_b16 a[8:9], v197 offset:16384
  v_mfma_f32_16x16x32_bf16 v[104:107], a[72:75], a[176:179], v[104:107]
  ds_read_b64_tr_b16 a[10:11], v197 offset:16896
  v_mfma_f32_16x16x32_bf16 v[108:111], a[76:79], a[176:179], v[108:111]
  s_add_u32 m0, s27, 12288
  s_waitcnt lgkmcnt(4)
  v_mfma_f32_16x16x32_bf16 v[80:83], a[80:83], a[180:183], v[80:83]
  ds_read_b128 a[188:191], v191 offset:28672
  v_mfma_f32_16x16x32_bf16 v[84:87], a[84:87], a[180:183], v[84:87]
  s_add_u32 s28, s55, 184320
  v_mfma_f32_16x16x32_bf16 v[88:91], a[88:91], a[180:183], v[88:91]
  buffer_load_dwordx4 v186, s[4:7], s28 offen  lds
  v_mfma_f32_16x16x32_bf16 v[92:95], a[92:95], a[180:183], v[92:95]
  ds_read_b64_tr_b16 a[12:13], v197 offset:24576
  s_waitcnt lgkmcnt(4)
  v_mfma_f32_16x16x32_bf16 v[64:67], a[96:99], a[184:187], v[64:67]
  ds_read_b128 a[176:179], v188 offset:16384
  v_mfma_f32_16x16x32_bf16 v[68:71], a[100:103], a[184:187], v[68:71]
  ds_read_b64_tr_b16 a[14:15], v197 offset:25088
  v_mfma_f32_16x16x32_bf16 v[72:75], a[104:107], a[184:187], v[72:75]
  s_add_u32 m0, s27, 20480
  v_mfma_f32_16x16x32_bf16 v[76:79], a[108:111], a[184:187], v[76:79]
  s_waitcnt lgkmcnt(3)
  v_mfma_f32_16x16x32_bf16 v[48:51], a[112:115], a[188:191], v[48:51]
  ds_read_b128 a[180:183], v188 offset:8192
  v_mfma_f32_16x16x32_bf16 v[52:55], a[116:119], a[188:191], v[52:55]
  s_add_u32 s28, s55, 163840
  buffer_load_dwordx4 v186, s[4:7], s28 offen  lds
  v_mfma_f32_16x16x32_bf16 v[56:59], a[120:123], a[188:191], v[56:59]
  v_cndmask_b32 v176, v176, v181, s[68:69]
  v_mfma_f32_16x16x32_bf16 v[60:63], a[124:127], a[188:191], v[60:63]
  s_add_u32 m0, s27, 49152
  s_waitcnt lgkmcnt(2)
  v_mfma_f32_16x16x32_bf16 v[32:35], a[128:131], a[176:179], v[32:35]
  v_cndmask_b32 v177, v177, v181, s[68:69]
  ds_read_b128 a[184:187], v193 offset:36864
  v_mfma_f32_16x16x32_bf16 v[36:39], a[132:135], a[176:179], v[36:39]
  s_add_u32 s28, s54, 81920
  v_mfma_f32_16x16x32_bf16 v[40:43], a[136:139], a[176:179], v[40:43]
  v_cndmask_b32 v178, v178, v181, s[68:69]
  buffer_load_dwordx4 v186, s[4:7], s28 offen  lds
  v_mfma_f32_16x16x32_bf16 v[44:47], a[140:143], a[176:179], v[44:47]
  s_add_u32 m0, s27, 86016
  s_waitcnt lgkmcnt(1)
  v_mfma_f32_16x16x32_bf16 v[16:19], a[128:131], a[180:183], v[16:19]
  v_cndmask_b32 v179, v179, v181, s[68:69]
  ds_read_b128 a[188:191], v194 offset:28672
  v_mfma_f32_16x16x32_bf16 v[20:23], a[132:135], a[180:183], v[20:23]
  s_add_u32 s28, s53, 0
  v_mfma_f32_16x16x32_bf16 v[24:27], a[136:139], a[180:183], v[24:27]
  buffer_load_dwordx4 v186, s[4:7], s28 offen  lds
  v_mfma_f32_16x16x32_bf16 v[28:31], a[140:143], a[180:183], v[28:31]
  v_mfma_f32_16x16x32_bf16 v[0:3], a[128:131], v[176:179], v[0:3]
  v_mfma_f32_16x16x32_bf16 v[4:7], a[132:135], v[176:179], v[4:7]
  v_mfma_f32_16x16x32_bf16 v[8:11], a[136:139], v[176:179], v[8:11]
  v_mfma_f32_16x16x32_bf16 v[12:15], a[140:143], v[176:179], v[12:15]
  s_waitcnt vmcnt(15)
  s_barrier
  s_add_u32 m0, s26, 16384
  s_waitcnt lgkmcnt(1)
  v_mfma_f32_16x16x32_bf16 v[160:163], a[16:19], a[184:187], v[160:163]
  ds_read_b128 v[176:179], v189 offset:0
  ds_read_b128 a[176:179], v195 offset:20480
  v_mfma_f32_16x16x32_bf16 v[164:167], a[20:23], a[184:187], v[164:167]
  s_add_u32 s24, s24, s25
  v_mfma_f32_16x16x32_bf16 v[168:171], a[24:27], a[184:187], v[168:171]
  v_mfma_f32_16x16x32_bf16 v[172:175], a[28:31], a[184:187], v[172:175]
  buffer_load_dwordx4 v182, s[8:11], s24 offen offset:0  lds
  s_waitcnt lgkmcnt(2)
  v_mfma_f32_16x16x32_bf16 v[144:147], a[32:35], a[188:191], v[144:147]
  ds_read_b128 a[180:183], v192 offset:16384
  v_mfma_f32_16x16x32_bf16 v[148:151], a[36:39], a[188:191], v[148:151]
  buffer_load_dwordx4 v183, s[8:11], s24 offen offset:1024  lds
  v_mfma_f32_16x16x32_bf16 v[152:155], a[40:43], a[188:191], v[152:155]
  v_mfma_f32_16x16x32_bf16 v[156:159], a[44:47], a[188:191], v[156:159]
  buffer_load_dwordx4 v184, s[8:11], s24 offen offset:2048  lds
  s_waitcnt lgkmcnt(1)
  v_mfma_f32_16x16x32_bf16 v[128:131], a[48:51], a[176:179], v[128:131]
  ds_read_b128 a[184:187], v193 offset:8192
  v_mfma_f32_16x16x32_bf16 v[132:135], a[52:55], a[176:179], v[132:135]
  buffer_load_dwordx4 v185, s[8:11], s24 offen offset:3072  lds
  v_mfma_f32_16x16x32_bf16 v[136:139], a[56:59], a[176:179], v[136:139]
  v_mfma_f32_16x16x32_bf16 v[140:143], a[60:63], a[176:179], v[140:143]
  ds_read_b64_tr_b16 a[16:17], v196 offset:32768
  s_waitcnt lgkmcnt(2)
  v_mfma_f32_16x16x32_bf16 v[112:115], a[64:67], a[180:183], v[112:115]
  ds_read_b128 a[188:191], v194 offset:0
  v_mfma_f32_16x16x32_bf16 v[116:119], a[68:71], a[180:183], v[116:119]
  ds_read_b64_tr_b16 a[18:19], v196 offset:33280
  v_mfma_f32_16x16x32_bf16 v[120:123], a[72:75], a[180:183], v[120:123]
  v_mfma_f32_16x16x32_bf16 v[124:127], a[76:79], a[180:183], v[124:127]
  ds_read_b64_tr_b16 a[20:21], v196 offset:40960
  s_waitcnt lgkmcnt(4)
  v_mfma_f32_16x16x32_bf16 v[96:99], a[80:83], a[184:187], v[96:99]
  ds_read_b128 a[176:179], v191 offset:36864
  v_mfma_f32_16x16x32_bf16 v[100:103], a[84:87], a[184:187], v[100:103]
  s_add_u32 m0, s27, 28672
  v_mfma_f32_16x16x32_bf16 v[104:107], a[88:91], a[184:187], v[104:107]
  v_mfma_f32_16x16x32_bf16 v[108:111], a[92:95], a[184:187], v[108:111]
  s_add_u32 s28, s55, 143360
  s_waitcnt lgkmcnt(3)
  v_mfma_f32_16x16x32_bf16 v[80:83], a[96:99], a[188:191], v[80:83]
  ds_read_b128 a[180:183], v188 offset:24576
  v_mfma_f32_16x16x32_bf16 v[84:87], a[100:103], a[188:191], v[84:87]
  buffer_load_dwordx4 v186, s[4:7], s28 offen  lds
  v_mfma_f32_16x16x32_bf16 v[88:91], a[104:107], a[188:191], v[88:91]
  v_mfma_f32_16x16x32_bf16 v[92:95], a[108:111], a[188:191], v[92:95]
  ds_read_b64_tr_b16 a[22:23], v196 offset:41472
  s_waitcnt lgkmcnt(2)
  v_mfma_f32_16x16x32_bf16 v[64:67], a[112:115], a[176:179], v[64:67]
  ds_read_b128 a[184:187], v189 offset:16384
  v_mfma_f32_16x16x32_bf16 v[68:71], a[116:119], a[176:179], v[68:71]
  ds_read_b64_tr_b16 a[24:25], v197 offset:32768
  v_mfma_f32_16x16x32_bf16 v[72:75], a[120:123], a[176:179], v[72:75]
  v_mfma_f32_16x16x32_bf16 v[76:79], a[124:127], a[176:179], v[76:79]
  ds_read_b64_tr_b16 a[26:27], v197 offset:33280
  s_waitcnt lgkmcnt(4)
  v_mfma_f32_16x16x32_bf16 v[48:51], a[128:131], a[180:183], v[48:51]
  ds_read_b128 a[188:191], v189 offset:8192
  v_mfma_f32_16x16x32_bf16 v[52:55], a[132:135], a[180:183], v[52:55]
  s_add_u32 m0, s27, 57344
  v_mfma_f32_16x16x32_bf16 v[56:59], a[136:139], a[180:183], v[56:59]
  v_cndmask_b32 v176, v176, v181, s[68:69]
  v_mfma_f32_16x16x32_bf16 v[60:63], a[140:143], a[180:183], v[60:63]
  s_add_u32 s28, s54, 61440
  s_waitcnt lgkmcnt(3)
  v_mfma_f32_16x16x32_bf16 v[32:35], a[0:3], a[184:187], v[32:35]
  v_cndmask_b32 v177, v177, v181, s[68:69]
  ds_read_b128 a[176:179], v194 offset:36864
  v_mfma_f32_16x16x32_bf16 v[36:39], a[4:7], a[184:187], v[36:39]
  buffer_load_dwordx4 v186, s[4:7], s28 offen  lds
  v_mfma_f32_16x16x32_bf16 v[40:43], a[8:11], a[184:187], v[40:43]
  v_cndmask_b32 v178, v178, v181, s[68:69]
  v_mfma_f32_16x16x32_bf16 v[44:47], a[12:15], a[184:187], v[44:47]
  ds_read_b64_tr_b16 a[28:29], v197 offset:40960
  s_waitcnt lgkmcnt(2)
  v_mfma_f32_16x16x32_bf16 v[16:19], a[0:3], a[188:191], v[16:19]
  v_cndmask_b32 v179, v179, v181, s[68:69]
  ds_read_b128 a[180:183], v195 offset:28672
  v_mfma_f32_16x16x32_bf16 v[20:23], a[4:7], a[188:191], v[20:23]
  ds_read_b64_tr_b16 a[30:31], v197 offset:41472
  v_mfma_f32_16x16x32_bf16 v[24:27], a[8:11], a[188:191], v[24:27]
  v_mfma_f32_16x16x32_bf16 v[28:31], a[12:15], a[188:191], v[28:31]
  v_mfma_f32_16x16x32_bf16 v[0:3], a[0:3], v[176:179], v[0:3]
  v_mfma_f32_16x16x32_bf16 v[4:7], a[4:7], v[176:179], v[4:7]
  v_mfma_f32_16x16x32_bf16 v[8:11], a[8:11], v[176:179], v[8:11]
  v_mfma_f32_16x16x32_bf16 v[12:15], a[12:15], v[176:179], v[12:15]
  s_waitcnt vmcnt(15)
  s_waitcnt lgkmcnt(0)
  s_barrier
  s_add_u32 m0, s26, 32768
  v_mfma_f32_16x16x32_bf16 v[160:163], a[32:35], a[176:179], v[160:163]
  ds_read_b128 v[176:179], v190 offset:0
  ds_read_b128 a[184:187], v192 offset:24576
  v_mfma_f32_16x16x32_bf16 v[164:167], a[36:39], a[176:179], v[164:167]
  s_add_u32 s24, s24, s25
  v_mfma_f32_16x16x32_bf16 v[168:171], a[40:43], a[176:179], v[168:171]
  v_mfma_f32_16x16x32_bf16 v[172:175], a[44:47], a[176:179], v[172:175]
  buffer_load_dwordx4 v182, s[8:11], s24 offen offset:0  lds
  v_mfma_f32_16x16x32_bf16 v[144:147], a[48:51], a[180:183], v[144:147]
  ds_read_b128 a[188:191], v193 offset:16384
  v_mfma_f32_16x16x32_bf16 v[148:151], a[52:55], a[180:183], v[148:151]
  buffer_load_dwordx4 v183, s[8:11], s24 offen offset:1024  lds
  v_mfma_f32_16x16x32_bf16 v[152:155], a[56:59], a[180:183], v[152:155]
  v_mfma_f32_16x16x32_bf16 v[156:159], a[60:63], a[180:183], v[156:159]
  buffer_load_dwordx4 v184, s[8:11], s24 offen offset:2048  lds
  s_waitcnt lgkmcnt(1)
  v_mfma_f32_16x16x32_bf16 v[128:131], a[64:67], a[184:187], v[128:131]
  ds_read_b128 a[176:179], v194 offset:8192
  v_mfma_f32_16x16x32_bf16 v[132:135], a[68:71], a[184:187], v[132:135]
  buffer_load_dwordx4 v185, s[8:11], s24 offen offset:3072  lds
  v_mfma_f32_16x16x32_bf16 v[136:139], a[72:75], a[184:187], v[136:139]
  v_mfma_f32_16x16x32_bf16 v[140:143], a[76:79], a[184:187], v[140:143]
  ds_read_b64_tr_b16 a[32:33], v196 offset:49152
  s_waitcnt lgkmcnt(2)
  v_mfma_f32_16x16x32_bf16 v[112:115], a[80:83], a[188:191], v[112:115]
  ds_read_b128 a[180:183], v195 offset:0
  v_mfma_f32_16x16x32_bf16 v[116:119], a[84:87], a[188:191], v[116:119]
  ds_read_b64_tr_b16 a[34:35], v196 offset:49664
  v_mfma_f32_16x16x32_bf16 v[120:123], a[88:91], a[188:191], v[120:123]
  v_mfma_f32_16x16x32_bf16 v[124:127], a[92:95], a[188:191], v[124:127]
  ds_read_b64_tr_b16 a[36:37], v196 offset:57344
  s_waitcnt lgkmcnt(4)
  v_mfma_f32_16x16x32_bf16 v[96:99], a[96:99], a[176:179], v[96:99]
  ds_read_b128 a[184:187], v188 offset:32768
  v_mfma_f32_16x16x32_bf16 v[100:103], a[100:103], a[176:179], v[100:103]
  s_add_u32 m0, s27, 36864
  v_mfma_f32_16x16x32_bf16 v[104:107], a[104:107], a[176:179], v[104:107]
  v_mfma_f32_16x16x32_bf16 v[108:111], a[108:111], a[176:179], v[108:111]
  s_add_u32 s28, s55, 122880
  s_waitcnt lgkmcnt(3)
  v_mfma_f32_16x16x32_bf16 v[80:83], a[112:115], a[180:183], v[80:83]
  ds_read_b128 a[188:191], v189 offset:24576
  v_mfma_f32_16x16x32_bf16 v[84:87], a[116:119], a[180:183], v[84:87]
  buffer_load_dwordx4 v186, s[4:7], s28 offen  lds
  v_mfma_f32_16x16x32_bf16 v[88:91], a[120:123], a[180:183], v[88:91]
  v_mfma_f32_16x16x32_bf16 v[92:95], a[124:127], a[180:183], v[92:95]
  ds_read_b64_tr_b16 a[38:39], v196 offset:57856
  s_waitcnt lgkmcnt(2)
  v_mfma_f32_16x16x32_bf16 v[64:67], a[128:131], a[184:187], v[64:67]
  ds_read_b128 a[176:179], v190 offset:16384
  v_mfma_f32_16x16x32_bf16 v[68:71], a[132:135], a[184:187], v[68:71]
  ds_read_b64_tr_b16 a[40:41], v197 offset:49152
  v_mfma_f32_16x16x32_bf16 v[72:75], a[136:139], a[184:187], v[72:75]
  v_mfma_f32_16x16x32_bf16 v[76:79], a[140:143], a[184:187], v[76:79]
  ds_read_b64_tr_b16 a[42:43], v197 offset:49664
  s_waitcnt lgkmcnt(4)
  v_mfma_f32_16x16x32_bf16 v[48:51], a[0:3], a[188:191], v[48:51]
  ds_read_b128 a[180:183], v190 offset:8192
  v_mfma_f32_16x16x32_bf16 v[52:55], a[4:7], a[188:191], v[52:55]
  s_add_u32 m0, s27, 65536
  v_mfma_f32_16x16x32_bf16 v[56:59], a[8:11], a[188:191], v[56:59]
  v_cndmask_b32 v176, v176, v181, s[68:69]
  v_mfma_f32_16x16x32_bf16 v[60:63], a[12:15], a[188:191], v[60:63]
  s_add_u32 s28, s54, 40960
  s_waitcnt lgkmcnt(3)
  v_mfma_f32_16x16x32_bf16 v[32:35], a[16:19], a[176:179], v[32:35]
  v_cndmask_b32 v177, v177, v181, s[68:69]
  ds_read_b128 a[184:187], v195 offset:36864
  v_mfma_f32_16x16x32_bf16 v[36:39], a[20:23], a[176:179], v[36:39]
  buffer_load_dwordx4 v186, s[4:7], s28 offen  lds
  v_mfma_f32_16x16x32_bf16 v[40:43], a[24:27], a[176:179], v[40:43]
  v_cndmask_b32 v178, v178, v181, s[68:69]
  v_mfma_f32_16x16x32_bf16 v[44:47], a[28:31], a[176:179], v[44:47]
  ds_read_b64_tr_b16 a[44:45], v197 offset:57344
  s_waitcnt lgkmcnt(2)
  v_mfma_f32_16x16x32_bf16 v[16:19], a[16:19], a[180:183], v[16:19]
  v_cndmask_b32 v179, v179, v181, s[68:69]
  ds_read_b128 a[188:191], v192 offset:32768
  v_mfma_f32_16x16x32_bf16 v[20:23], a[20:23], a[180:183], v[20:23]
  ds_read_b64_tr_b16 a[46:47], v197 offset:57856
  v_mfma_f32_16x16x32_bf16 v[24:27], a[24:27], a[180:183], v[24:27]
  v_mfma_f32_16x16x32_bf16 v[28:31], a[28:31], a[180:183], v[28:31]
  v_mfma_f32_16x16x32_bf16 v[0:3], a[16:19], v[176:179], v[0:3]
  v_mfma_f32_16x16x32_bf16 v[4:7], a[20:23], v[176:179], v[4:7]
  v_mfma_f32_16x16x32_bf16 v[8:11], a[24:27], v[176:179], v[8:11]
  v_mfma_f32_16x16x32_bf16 v[12:15], a[28:31], v[176:179], v[12:15]
  s_waitcnt vmcnt(12)
  s_waitcnt lgkmcnt(0)
  s_barrier
  s_add_u32 m0, s26, 49152
  v_mfma_f32_16x16x32_bf16 v[160:163], a[48:51], a[184:187], v[160:163]
  ds_read_b128 v[176:179], v191 offset:0
  ds_read_b128 a[176:179], v193 offset:24576
  v_mfma_f32_16x16x32_bf16 v[164:167], a[52:55], a[184:187], v[164:167]
  s_add_u32 s24, s24, s25
  v_mfma_f32_16x16x32_bf16 v[168:171], a[56:59], a[184:187], v[168:171]
  v_mfma_f32_16x16x32_bf16 v[172:175], a[60:63], a[184:187], v[172:175]
  buffer_load_dwordx4 v182, s[8:11], s24 offen offset:0  lds
  v_mfma_f32_16x16x32_bf16 v[144:147], a[64:67], a[188:191], v[144:147]
  ds_read_b128 a[180:183], v194 offset:16384
  v_mfma_f32_16x16x32_bf16 v[148:151], a[68:71], a[188:191], v[148:151]
  buffer_load_dwordx4 v183, s[8:11], s24 offen offset:1024  lds
  v_mfma_f32_16x16x32_bf16 v[152:155], a[72:75], a[188:191], v[152:155]
  v_mfma_f32_16x16x32_bf16 v[156:159], a[76:79], a[188:191], v[156:159]
  buffer_load_dwordx4 v184, s[8:11], s24 offen offset:2048  lds
  s_waitcnt lgkmcnt(1)
  v_mfma_f32_16x16x32_bf16 v[128:131], a[80:83], a[176:179], v[128:131]
  ds_read_b128 a[184:187], v195 offset:8192
  v_mfma_f32_16x16x32_bf16 v[132:135], a[84:87], a[176:179], v[132:135]
  buffer_load_dwordx4 v185, s[8:11], s24 offen offset:3072  lds
  v_mfma_f32_16x16x32_bf16 v[136:139], a[88:91], a[176:179], v[136:139]
  v_mfma_f32_16x16x32_bf16 v[140:143], a[92:95], a[176:179], v[140:143]
  ds_read_b64_tr_b16 a[48:49], v196 offset:0
  s_waitcnt lgkmcnt(2)
  v_mfma_f32_16x16x32_bf16 v[112:115], a[96:99], a[180:183], v[112:115]
  ds_read_b128 a[188:191], v188 offset:40960
  v_mfma_f32_16x16x32_bf16 v[116:119], a[100:103], a[180:183], v[116:119]
  ds_read_b64_tr_b16 a[50:51], v196 offset:512
  v_mfma_f32_16x16x32_bf16 v[120:123], a[104:107], a[180:183], v[120:123]
  v_mfma_f32_16x16x32_bf16 v[124:127], a[108:111], a[180:183], v[124:127]
  ds_read_b64_tr_b16 a[52:53], v196 offset:8192
  s_waitcnt lgkmcnt(4)
  v_mfma_f32_16x16x32_bf16 v[96:99], a[112:115], a[184:187], v[96:99]
  ds_read_b128 a[176:179], v189 offset:32768
  v_mfma_f32_16x16x32_bf16 v[100:103], a[116:119], a[184:187], v[100:103]
  s_add_u32 m0, s27, 45056
  v_mfma_f32_16x16x32_bf16 v[104:107], a[120:123], a[184:187], v[104:107]
  v_mfma_f32_16x16x32_bf16 v[108:111], a[124:127], a[184:187], v[108:111]
  s_add_u32 s28, s55, 102400
  s_waitcnt lgkmcnt(3)
  v_mfma_f32_16x16x32_bf16 v[80:83], a[128:131], a[188:191], v[80:83]
  ds_read_b128 a[180:183], v190 offset:24576
  v_mfma_f32_16x16x32_bf16 v[84:87], a[132:135], a[188:191], v[84:87]
  buffer_load_dwordx4 v186, s[4:7], s28 offen  lds
  v_mfma_f32_16x16x32_bf16 v[88:91], a[136:139], a[188:191], v[88:91]
  v_mfma_f32_16x16x32_bf16 v[92:95], a[140:143], a[188:191], v[92:95]
  ds_read_b64_tr_b16 a[54:55], v196 offset:8704
  s_waitcnt lgkmcnt(2)
  v_mfma_f32_16x16x32_bf16 v[64:67], a[0:3], a[176:179], v[64:67]
  ds_read_b128 a[184:187], v191 offset:16384
  v_mfma_f32_16x16x32_bf16 v[68:71], a[4:7], a[176:179], v[68:71]
  ds_read_b64_tr_b16 a[56:57], v197 offset:0
  v_mfma_f32_16x16x32_bf16 v[72:75], a[8:11], a[176:179], v[72:75]
  v_mfma_f32_16x16x32_bf16 v[76:79], a[12:15], a[176:179], v[76:79]
  ds_read_b64_tr_b16 a[58:59], v197 offset:512
  s_waitcnt lgkmcnt(4)
  v_mfma_f32_16x16x32_bf16 v[48:51], a[16:19], a[180:183], v[48:51]
  ds_read_b128 a[188:191], v191 offset:8192
  v_mfma_f32_16x16x32_bf16 v[52:55], a[20:23], a[180:183], v[52:55]
  s_add_u32 m0, s27, 73728
  v_mfma_f32_16x16x32_bf16 v[56:59], a[24:27], a[180:183], v[56:59]
  v_cndmask_b32 v176, v176, v181, s[68:69]
  v_mfma_f32_16x16x32_bf16 v[60:63], a[28:31], a[180:183], v[60:63]
  s_add_u32 s28, s54, 20480
  s_waitcnt lgkmcnt(3)
  v_mfma_f32_16x16x32_bf16 v[32:35], a[32:35], a[184:187], v[32:35]
  v_cndmask_b32 v177, v177, v181, s[68:69]
  ds_read_b128 a[176:179], v192 offset:40960
  v_mfma_f32_16x16x32_bf16 v[36:39], a[36:39], a[184:187], v[36:39]
  buffer_load_dwordx4 v186, s[4:7], s28 offen  lds
  v_mfma_f32_16x16x32_bf16 v[40:43], a[40:43], a[184:187], v[40:43]
  v_cndmask_b32 v178, v178, v181, s[68:69]
  v_mfma_f32_16x16x32_bf16 v[44:47], a[44:47], a[184:187], v[44:47]
  ds_read_b64_tr_b16 a[60:61], v197 offset:8192
  s_waitcnt lgkmcnt(2)
  v_mfma_f32_16x16x32_bf16 v[16:19], a[32:35], a[188:191], v[16:19]
  v_cndmask_b32 v179, v179, v181, s[68:69]
  ds_read_b128 a[180:183], v193 offset:32768
  v_mfma_f32_16x16x32_bf16 v[20:23], a[36:39], a[188:191], v[20:23]
  ds_read_b64_tr_b16 a[62:63], v197 offset:8704
  v_mfma_f32_16x16x32_bf16 v[24:27], a[40:43], a[188:191], v[24:27]
  v_mfma_f32_16x16x32_bf16 v[28:31], a[44:47], a[188:191], v[28:31]
  v_mfma_f32_16x16x32_bf16 v[0:3], a[32:35], v[176:179], v[0:3]
  v_mfma_f32_16x16x32_bf16 v[4:7], a[36:39], v[176:179], v[4:7]
  v_mfma_f32_16x16x32_bf16 v[8:11], a[40:43], v[176:179], v[8:11]
  v_mfma_f32_16x16x32_bf16 v[12:15], a[44:47], v[176:179], v[12:15]
  s_waitcnt vmcnt(12)
  s_waitcnt lgkmcnt(0)
  s_barrier
  s_add_u32 m0, s26, 0
  v_mfma_f32_16x16x32_bf16 v[160:163], a[64:67], a[176:179], v[160:163]
  ds_read_b128 v[176:179], v188 offset:4096
  ds_read_b128 a[184:187], v194 offset:24576
  v_mfma_f32_16x16x32_bf16 v[164:167], a[68:71], a[176:179], v[164:167]
  s_mov_b32 s24, s61
  v_mfma_f32_16x16x32_bf16 v[168:171], a[72:75], a[176:179], v[168:171]
  buffer_load_dwordx4 v182, s[8:11], s24 offen offset:0  lds
  buffer_load_dwordx4 v183, s[8:11], s24 offen offset:1024  lds
  v_mfma_f32_16x16x32_bf16 v[172:175], a[76:79], a[176:179], v[172:175]
  buffer_load_dwordx4 v184, s[8:11], s24 offen offset:2048  lds
  v_mfma_f32_16x16x32_bf16 v[144:147], a[80:83], a[180:183], v[144:147]
  ds_read_b128 a[188:191], v195 offset:16384
  v_mfma_f32_16x16x32_bf16 v[148:151], a[84:87], a[180:183], v[148:151]
  buffer_load_dwordx4 v185, s[8:11], s24 offen offset:3072  lds
  v_mfma_f32_16x16x32_bf16 v[152:155], a[88:91], a[180:183], v[152:155]
  ds_read_b64_tr_b16 a[64:65], v196 offset:16384
  ds_read_b64_tr_b16 a[66:67], v196 offset:16896
  v_mfma_f32_16x16x32_bf16 v[156:159], a[92:95], a[180:183], v[156:159]
  ds_read_b64_tr_b16 a[68:69], v196 offset:24576
  s_waitcnt lgkmcnt(4)
  v_mfma_f32_16x16x32_bf16 v[128:131], a[96:99], a[184:187], v[128:131]
  ds_read_b128 a[176:179], v192 offset:4096
  v_mfma_f32_16x16x32_bf16 v[132:135], a[100:103], a[184:187], v[132:135]
  s_add_u32 m0, s27, 0
  v_mfma_f32_16x16x32_bf16 v[136:139], a[104:107], a[184:187], v[136:139]
  buffer_load_dwordx4 v187, s[4:7], s56 offen  lds
  ds_read_b64_tr_b16 a[70:71], v196 offset:25088
  v_mfma_f32_16x16x32_bf16 v[140:143], a[108:111], a[184:187], v[140:143]
  ds_read_b64_tr_b16 a[72:73], v197 offset:16384
  s_waitcnt lgkmcnt(6)
  v_mfma_f32_16x16x32_bf16 v[112:115], a[112:115], a[188:191], v[112:115]
  ds_read_b128 a[180:183], v189 offset:40960
  v_mfma_f32_16x16x32_bf16 v[116:119], a[116:119], a[188:191], v[116:119]
  ds_read_b64_tr_b16 a[74:75], v197 offset:16896
  v_mfma_f32_16x16x32_bf16 v[120:123], a[120:123], a[188:191], v[120:123]
  s_add_u32 m0, s27, 8192
  v_mfma_f32_16x16x32_bf16 v[124:127], a[124:127], a[188:191], v[124:127]
  s_add_u32 s28, s56, 184320
  s_waitcnt lgkmcnt(4)
  v_mfma_f32_16x16x32_bf16 v[96:99], a[128:131], a[176:179], v[96:99]
  ds_read_b128 a[184:187], v190 offset:32768
  v_mfma_f32_16x16x32_bf16 v[100:103], a[132:135], a[176:179], v[100:103]
  buffer_load_dwordx4 v186, s[4:7], s28 offen  lds
  v_mfma_f32_16x16x32_bf16 v[104:107], a[136:139], a[176:179], v[104:107]
  ds_read_b64_tr_b16 a[76:77], v197 offset:24576
  ds_read_b64_tr_b16 a[78:79], v197 offset:25088
  v_mfma_f32_16x16x32_bf16 v[108:111], a[140:143], a[176:179], v[108:111]
  s_add_u32 m0, s27, 16384
  s_waitcnt lgkmcnt(4)
  v_mfma_f32_16x16x32_bf16 v[80:83], a[0:3], a[180:183], v[80:83]
  ds_read_b128 a[188:191], v191 offset:24576
  v_mfma_f32_16x16x32_bf16 v[84:87], a[4:7], a[180:183], v[84:87]
  s_add_u32 s28, s56, 163840
  v_mfma_f32_16x16x32_bf16 v[88:91], a[8:11], a[180:183], v[88:91]
  buffer_load_dwordx4 v186, s[4:7], s28 offen  lds
  s_add_u32 m0, s27, 53248
  v_mfma_f32_16x16x32_bf16 v[92:95], a[12:15], a[180:183], v[92:95]
  s_add_u32 s28, s55, 81920
  s_waitcnt lgkmcnt(3)
  v_mfma_f32_16x16x32_bf16 v[64:67], a[16:19], a[184:187], v[64:67]
  ds_read_b128 a[176:179], v188 offset:20480
  v_mfma_f32_16x16x32_bf16 v[68:71], a[20:23], a[184:187], v[68:71]
  buffer_load_dwordx4 v186, s[4:7], s28 offen  lds
  v_mfma_f32_16x16x32_bf16 v[72:75], a[24:27], a[184:187], v[72:75]
  s_add_u32 m0, s27, 81920
  v_mfma_f32_16x16x32_bf16 v[76:79], a[28:31], a[184:187], v[76:79]
  s_add_u32 s28, s54, 0
  s_waitcnt lgkmcnt(1)
  v_mfma_f32_16x16x32_bf16 v[48:51], a[32:35], a[188:191], v[48:51]
  ds_read_b128 a[180:183], v188 offset:12288
  v_mfma_f32_16x16x32_bf16 v[52:55], a[36:39], a[188:191], v[52:55]
  buffer_load_dwordx4 v186, s[4:7], s28 offen  lds
  s_mov_b32 s80, 757760
  v_mfma_f32_16x16x32_bf16 v[56:59], a[40:43], a[188:191], v[56:59]
  v_cndmask_b32 v176, v176, v181, s[68:69]
  s_mov_b32 s81, 681984
  v_mfma_f32_16x16x32_bf16 v[60:63], a[44:47], a[188:191], v[60:63]
  s_mov_b32 s82, 606208
  s_waitcnt lgkmcnt(1)
  v_mfma_f32_16x16x32_bf16 v[32:35], a[48:51], a[176:179], v[32:35]
  v_cndmask_b32 v177, v177, v181, s[68:69]
  ds_read_b128 a[184:187], v193 offset:40960
  v_mfma_f32_16x16x32_bf16 v[36:39], a[52:55], a[176:179], v[36:39]
  s_mov_b32 s83, 530432
  s_mov_b32 s84, 454656
  v_mfma_f32_16x16x32_bf16 v[40:43], a[56:59], a[176:179], v[40:43]
  v_cndmask_b32 v178, v178, v181, s[68:69]
  s_mov_b32 s85, 378880
  v_mfma_f32_16x16x32_bf16 v[44:47], a[60:63], a[176:179], v[44:47]
  s_mov_b32 s86, 303104
  s_waitcnt lgkmcnt(1)
  v_mfma_f32_16x16x32_bf16 v[16:19], a[48:51], a[180:183], v[16:19]
  v_cndmask_b32 v179, v179, v181, s[68:69]
  ds_read_b128 a[188:191], v194 offset:32768
  v_mfma_f32_16x16x32_bf16 v[20:23], a[52:55], a[180:183], v[20:23]
  s_mov_b32 s87, 227328
  v_mfma_f32_16x16x32_bf16 v[24:27], a[56:59], a[180:183], v[24:27]
  s_mov_b32 s88, 151552
  s_mov_b32 s89, 75776
  v_mfma_f32_16x16x32_bf16 v[28:31], a[60:63], a[180:183], v[28:31]
  v_mfma_f32_16x16x32_bf16 v[0:3], a[48:51], v[176:179], v[0:3]
  v_mfma_f32_16x16x32_bf16 v[4:7], a[52:55], v[176:179], v[4:7]
  v_mfma_f32_16x16x32_bf16 v[8:11], a[56:59], v[176:179], v[8:11]
  v_mfma_f32_16x16x32_bf16 v[12:15], a[60:63], v[176:179], v[12:15]
  s_waitcnt vmcnt(15)
  s_barrier
  s_add_u32 m0, s26, 16384
  s_waitcnt lgkmcnt(1)
  v_mfma_f32_16x16x32_bf16 v[160:163], a[80:83], a[184:187], v[160:163]
  ds_read_b128 v[176:179], v189 offset:4096
  ds_read_b128 a[176:179], v195 offset:24576
  v_mfma_f32_16x16x32_bf16 v[164:167], a[84:87], a[184:187], v[164:167]
  s_add_u32 s24, s24, s25
  v_mfma_f32_16x16x32_bf16 v[168:171], a[88:91], a[184:187], v[168:171]
  v_mfma_f32_16x16x32_bf16 v[172:175], a[92:95], a[184:187], v[172:175]
  buffer_load_dwordx4 v182, s[8:11], s24 offen offset:0  lds
  s_waitcnt lgkmcnt(2)
  v_mfma_f32_16x16x32_bf16 v[144:147], a[96:99], a[188:191], v[144:147]
  ds_read_b128 a[180:183], v192 offset:12288
  v_mfma_f32_16x16x32_bf16 v[148:151], a[100:103], a[188:191], v[148:151]
  buffer_load_dwordx4 v183, s[8:11], s24 offen offset:1024  lds
  v_mfma_f32_16x16x32_bf16 v[152:155], a[104:107], a[188:191], v[152:155]
  v_mfma_f32_16x16x32_bf16 v[156:159], a[108:111], a[188:191], v[156:159]
  buffer_load_dwordx4 v184, s[8:11], s24 offen offset:2048  lds
  s_waitcnt lgkmcnt(1)
  v_mfma_f32_16x16x32_bf16 v[128:131], a[112:115], a[176:179], v[128:131]
  ds_read_b128 a[184:187], v193 offset:4096
  v_mfma_f32_16x16x32_bf16 v[132:135], a[116:119], a[176:179], v[132:135]
  buffer_load_dwordx4 v185, s[8:11], s24 offen offset:3072  lds
  v_mfma_f32_16x16x32_bf16 v[136:139], a[120:123], a[176:179], v[136:139]
  v_mfma_f32_16x16x32_bf16 v[140:143], a[124:127], a[176:179], v[140:143]
  ds_read_b64_tr_b16 a[80:81], v196 offset:32768
  s_waitcnt lgkmcnt(2)
  v_mfma_f32_16x16x32_bf16 v[112:115], a[128:131], a[180:183], v[112:115]
  ds_read_b128 a[188:191], v190 offset:40960
  v_mfma_f32_16x16x32_bf16 v[116:119], a[132:135], a[180:183], v[116:119]
  ds_read_b64_tr_b16 a[82:83], v196 offset:33280
  v_mfma_f32_16x16x32_bf16 v[120:123], a[136:139], a[180:183], v[120:123]
  v_mfma_f32_16x16x32_bf16 v[124:127], a[140:143], a[180:183], v[124:127]
  ds_read_b64_tr_b16 a[84:85], v196 offset:40960
  s_waitcnt lgkmcnt(4)
  v_mfma_f32_16x16x32_bf16 v[96:99], a[0:3], a[184:187], v[96:99]
  ds_read_b128 a[176:179], v191 offset:32768
  v_mfma_f32_16x16x32_bf16 v[100:103], a[4:7], a[184:187], v[100:103]
  s_add_u32 m0, s27, 24576
  v_mfma_f32_16x16x32_bf16 v[104:107], a[8:11], a[184:187], v[104:107]
  v_mfma_f32_16x16x32_bf16 v[108:111], a[12:15], a[184:187], v[108:111]
  s_add_u32 s28, s56, 143360
  s_waitcnt lgkmcnt(3)
  v_mfma_f32_16x16x32_bf16 v[80:83], a[16:19], a[188:191], v[80:83]
  ds_read_b128 a[180:183], v188 offset:28672
  v_mfma_f32_16x16x32_bf16 v[84:87], a[20:23], a[188:191], v[84:87]
  buffer_load_dwordx4 v186, s[4:7], s28 offen  lds
  v_mfma_f32_16x16x32_bf16 v[88:91], a[24:27], a[188:191], v[88:91]
  v_mfma_f32_16x16x32_bf16 v[92:95], a[28:31], a[188:191], v[92:95]
  ds_read_b64_tr_b16 a[86:87], v196 offset:41472
  s_waitcnt lgkmcnt(2)
  v_mfma_f32_16x16x32_bf16 v[64:67], a[32:35], a[176:179], v[64:67]
  ds_read_b128 a[184:187], v189 offset:20480
  v_mfma_f32_16x16x32_bf16 v[68:71], a[36:39], a[176:179], v[68:71]
  ds_read_b64_tr_b16 a[88:89], v197 offset:32768
  v_mfma_f32_16x16x32_bf16 v[72:75], a[40:43], a[176:179], v[72:75]
  v_mfma_f32_16x16x32_bf16 v[76:79], a[44:47], a[176:179], v[76:79]
  ds_read_b64_tr_b16 a[90:91], v197 offset:33280
  s_waitcnt lgkmcnt(4)
  v_mfma_f32_16x16x32_bf16 v[48:51], a[48:51], a[180:183], v[48:51]
  ds_read_b128 a[188:191], v189 offset:12288
  v_mfma_f32_16x16x32_bf16 v[52:55], a[52:55], a[180:183], v[52:55]
  s_add_u32 m0, s27, 61440
  v_mfma_f32_16x16x32_bf16 v[56:59], a[56:59], a[180:183], v[56:59]
  v_cndmask_b32 v176, v176, v181, s[68:69]
  v_mfma_f32_16x16x32_bf16 v[60:63], a[60:63], a[180:183], v[60:63]
  s_add_u32 s28, s55, 61440
  s_waitcnt lgkmcnt(3)
  v_mfma_f32_16x16x32_bf16 v[32:35], a[64:67], a[184:187], v[32:35]
  v_cndmask_b32 v177, v177, v181, s[68:69]
  ds_read_b128 a[176:179], v194 offset:40960
  v_mfma_f32_16x16x32_bf16 v[36:39], a[68:71], a[184:187], v[36:39]
  buffer_load_dwordx4 v186, s[4:7], s28 offen  lds
  v_mfma_f32_16x16x32_bf16 v[40:43], a[72:75], a[184:187], v[40:43]
  v_cndmask_b32 v178, v178, v181, s[68:69]
  v_mfma_f32_16x16x32_bf16 v[44:47], a[76:79], a[184:187], v[44:47]
  ds_read_b64_tr_b16 a[92:93], v197 offset:40960
  s_waitcnt lgkmcnt(2)
  v_mfma_f32_16x16x32_bf16 v[16:19], a[64:67], a[188:191], v[16:19]
  v_cndmask_b32 v179, v179, v181, s[68:69]
  ds_read_b128 a[180:183], v195 offset:32768
  v_mfma_f32_16x16x32_bf16 v[20:23], a[68:71], a[188:191], v[20:23]
  ds_read_b64_tr_b16 a[94:95], v197 offset:41472
  v_mfma_f32_16x16x32_bf16 v[24:27], a[72:75], a[188:191], v[24:27]
  v_mfma_f32_16x16x32_bf16 v[28:31], a[76:79], a[188:191], v[28:31]
  v_mfma_f32_16x16x32_bf16 v[0:3], a[64:67], v[176:179], v[0:3]
  v_mfma_f32_16x16x32_bf16 v[4:7], a[68:71], v[176:179], v[4:7]
  v_mfma_f32_16x16x32_bf16 v[8:11], a[72:75], v[176:179], v[8:11]
  v_mfma_f32_16x16x32_bf16 v[12:15], a[76:79], v[176:179], v[12:15]
  s_waitcnt vmcnt(15)
  s_waitcnt lgkmcnt(0)
  s_barrier
  s_add_u32 m0, s26, 32768
  v_mfma_f32_16x16x32_bf16 v[160:163], a[96:99], a[176:179], v[160:163]
  ds_read_b128 v[176:179], v190 offset:4096
  ds_read_b128 a[184:187], v192 offset:20480
  v_mfma_f32_16x16x32_bf16 v[164:167], a[100:103], a[176:179], v[164:167]
  s_add_u32 s24, s24, s25
  v_mfma_f32_16x16x32_bf16 v[168:171], a[104:107], a[176:179], v[168:171]
  buffer_load_dwordx4 v182, s[8:11], s24 offen offset:0  lds
  v_mfma_f32_16x16x32_bf16 v[172:175], a[108:111], a[176:179], v[172:175]
  v_mfma_f32_16x16x32_bf16 v[144:147], a[112:115], a[180:183], v[144:147]
  ds_read_b128 a[188:191], v193 offset:12288
  v_mfma_f32_16x16x32_bf16 v[148:151], a[116:119], a[180:183], v[148:151]
  buffer_load_dwordx4 v183, s[8:11], s24 offen offset:1024  lds
  v_mfma_f32_16x16x32_bf16 v[152:155], a[120:123], a[180:183], v[152:155]
  buffer_load_dwordx4 v184, s[8:11], s24 offen offset:2048  lds
  v_mfma_f32_16x16x32_bf16 v[156:159], a[124:127], a[180:183], v[156:159]
  s_waitcnt lgkmcnt(1)
  v_mfma_f32_16x16x32_bf16 v[128:131], a[128:131], a[184:187], v[128:131]
  ds_read_b128 a[176:179], v194 offset:4096
  v_mfma_f32_16x16x32_bf16 v[132:135], a[132:135], a[184:187], v[132:135]
  buffer_load_dwordx4 v185, s[8:11], s24 offen offset:3072  lds
  v_mfma_f32_16x16x32_bf16 v[136:139], a[136:139], a[184:187], v[136:139]
  ds_read_b64_tr_b16 a[96:97], v196 offset:49152
  v_mfma_f32_16x16x32_bf16 v[140:143], a[140:143], a[184:187], v[140:143]
  s_waitcnt lgkmcnt(2)
  v_mfma_f32_16x16x32_bf16 v[112:115], a[0:3], a[188:191], v[112:115]
  ds_read_b128 a[180:183], v191 offset:40960
  v_mfma_f32_16x16x32_bf16 v[116:119], a[4:7], a[188:191], v[116:119]
  ds_read_b64_tr_b16 a[98:99], v196 offset:49664
  v_mfma_f32_16x16x32_bf16 v[120:123], a[8:11], a[188:191], v[120:123]
  ds_read_b64_tr_b16 a[100:101], v196 offset:57344
  v_mfma_f32_16x16x32_bf16 v[124:127], a[12:15], a[188:191], v[124:127]
  s_add_u32 m0, s27, 32768
  s_waitcnt lgkmcnt(4)
  v_mfma_f32_16x16x32_bf16 v[96:99], a[16:19], a[176:179], v[96:99]
  ds_read_b128 a[184:187], v188 offset:36864
  v_mfma_f32_16x16x32_bf16 v[100:103], a[20:23], a[176:179], v[100:103]
  s_add_u32 s28, s56, 122880
  v_mfma_f32_16x16x32_bf16 v[104:107], a[24:27], a[176:179], v[104:107]
  v_mfma_f32_16x16x32_bf16 v[108:111], a[28:31], a[176:179], v[108:111]
  buffer_load_dwordx4 v186, s[4:7], s28 offen  lds
  s_waitcnt lgkmcnt(3)
  v_mfma_f32_16x16x32_bf16 v[80:83], a[32:35], a[180:183], v[80:83]
  ds_read_b128 a[188:191], v189 offset:28672
  v_mfma_f32_16x16x32_bf16 v[84:87], a[36:39], a[180:183], v[84:87]
  ds_read_b64_tr_b16 a[102:103], v196 offset:57856
  v_mfma_f32_16x16x32_bf16 v[88:91], a[40:43], a[180:183], v[88:91]
  v_mfma_f32_16x16x32_bf16 v[92:95], a[44:47], a[180:183], v[92:95]
  ds_read_b64_tr_b16 a[104:105], v197 offset:49152
  s_waitcnt lgkmcnt(3)
  v_mfma_f32_16x16x32_bf16 v[64:67], a[48:51], a[184:187], v[64:67]
  ds_read_b128 a[176:179], v190 offset:20480
  v_mfma_f32_16x16x32_bf16 v[68:71], a[52:55], a[184:187], v[68:71]
  ds_read_b64_tr_b16 a[106:107], v197 offset:49664
  v_mfma_f32_16x16x32_bf16 v[72:75], a[56:59], a[184:187], v[72:75]
  s_add_u32 m0, s27, 69632
  v_mfma_f32_16x16x32_bf16 v[76:79], a[60:63], a[184:187], v[76:79]
  s_waitcnt lgkmcnt(4)
  v_mfma_f32_16x16x32_bf16 v[48:51], a[64:67], a[188:191], v[48:51]
  ds_read_b128 a[180:183], v190 offset:12288
  v_mfma_f32_16x16x32_bf16 v[52:55], a[68:71], a[188:191], v[52:55]
  s_add_u32 s28, s55, 40960
  v_mfma_f32_16x16x32_bf16 v[56:59], a[72:75], a[188:191], v[56:59]
  v_cndmask_b32 v176, v176, v181, s[68:69]
  buffer_load_dwordx4 v186, s[4:7], s28 offen  lds
  v_mfma_f32_16x16x32_bf16 v[60:63], a[76:79], a[188:191], v[60:63]
  s_waitcnt lgkmcnt(2)
  v_mfma_f32_16x16x32_bf16 v[32:35], a[80:83], a[176:179], v[32:35]
  v_cndmask_b32 v177, v177, v181, s[68:69]
  ds_read_b128 a[184:187], v195 offset:40960
  v_mfma_f32_16x16x32_bf16 v[36:39], a[84:87], a[176:179], v[36:39]
  ds_read_b64_tr_b16 a[108:109], v197 offset:57344
  v_mfma_f32_16x16x32_bf16 v[40:43], a[88:91], a[176:179], v[40:43]
  v_cndmask_b32 v178, v178, v181, s[68:69]
  ds_read_b64_tr_b16 a[110:111], v197 offset:57856
  v_mfma_f32_16x16x32_bf16 v[44:47], a[92:95], a[176:179], v[44:47]
  s_waitcnt lgkmcnt(3)
  v_mfma_f32_16x16x32_bf16 v[16:19], a[80:83], a[180:183], v[16:19]
  v_cndmask_b32 v179, v179, v181, s[68:69]
  ds_read_b128 a[188:191], v192 offset:28672
  v_mfma_f32_16x16x32_bf16 v[20:23], a[84:87], a[180:183], v[20:23]
  v_lshlrev_b32 v220, 2, v244
  v_mfma_f32_16x16x32_bf16 v[24:27], a[88:91], a[180:183], v[24:27]
  buffer_load_dword v221, v220, s[16:19], 0 offen sc1
  v_mfma_f32_16x16x32_bf16 v[28:31], a[92:95], a[180:183], v[28:31]
  v_mfma_f32_16x16x32_bf16 v[0:3], a[80:83], v[176:179], v[0:3]
  v_mfma_f32_16x16x32_bf16 v[4:7], a[84:87], v[176:179], v[4:7]
  v_mfma_f32_16x16x32_bf16 v[8:11], a[88:91], v[176:179], v[8:11]
  v_mfma_f32_16x16x32_bf16 v[12:15], a[92:95], v[176:179], v[12:15]
  s_waitcnt vmcnt(13)
  s_waitcnt lgkmcnt(1)
  s_barrier
  s_add_u32 m0, s26, 49152
  v_mfma_f32_16x16x32_bf16 v[160:163], a[112:115], a[184:187], v[160:163]
  ds_read_b128 v[176:179], v191 offset:4096
  ds_read_b128 a[176:179], v193 offset:20480
  v_mfma_f32_16x16x32_bf16 v[164:167], a[116:119], a[184:187], v[164:167]
  s_add_u32 s24, s24, s25
  v_mfma_f32_16x16x32_bf16 v[168:171], a[120:123], a[184:187], v[168:171]
  v_mfma_f32_16x16x32_bf16 v[172:175], a[124:127], a[184:187], v[172:175]
  buffer_load_dwordx4 v182, s[8:11], s24 offen offset:0  lds
  s_waitcnt lgkmcnt(2)
  v_mfma_f32_16x16x32_bf16 v[144:147], a[128:131], a[188:191], v[144:147]
  ds_read_b128 a[180:183], v194 offset:12288
  v_mfma_f32_16x16x32_bf16 v[148:151], a[132:135], a[188:191], v[148:151]
  buffer_load_dwordx4 v183, s[8:11], s24 offen offset:1024  lds
  v_mfma_f32_16x16x32_bf16 v[152:155], a[136:139], a[188:191], v[152:155]
  v_mfma_f32_16x16x32_bf16 v[156:159], a[140:143], a[188:191], v[156:159]
  buffer_load_dwordx4 v184, s[8:11], s24 offen offset:2048  lds
  s_waitcnt lgkmcnt(1)
  v_mfma_f32_16x16x32_bf16 v[128:131], a[0:3], a[176:179], v[128:131]
  ds_read_b128 a[184:187], v195 offset:4096
  v_mfma_f32_16x16x32_bf16 v[132:135], a[4:7], a[176:179], v[132:135]
  buffer_load_dwordx4 v185, s[8:11], s24 offen offset:3072  lds
  v_mfma_f32_16x16x32_bf16 v[136:139], a[8:11], a[176:179], v[136:139]
  v_mfma_f32_16x16x32_bf16 v[140:143], a[12:15], a[176:179], v[140:143]
  ds_read_b64_tr_b16 a[112:113], v196 offset:0
  s_waitcnt lgkmcnt(2)
  v_mfma_f32_16x16x32_bf16 v[112:115], a[16:19], a[180:183], v[112:115]
  ds_read_b128 a[188:191], v192 offset:0
  v_mfma_f32_16x16x32_bf16 v[116:119], a[20:23], a[180:183], v[116:119]
  ds_read_b64_tr_b16 a[114:115], v196 offset:512
  v_mfma_f32_16x16x32_bf16 v[120:123], a[24:27], a[180:183], v[120:123]
  v_mfma_f32_16x16x32_bf16 v[124:127], a[28:31], a[180:183], v[124:127]
  ds_read_b64_tr_b16 a[116:117], v196 offset:8192
  s_waitcnt lgkmcnt(4)
  v_mfma_f32_16x16x32_bf16 v[96:99], a[32:35], a[184:187], v[96:99]
  ds_read_b128 a[176:179], v189 offset:36864
  v_mfma_f32_16x16x32_bf16 v[100:103], a[36:39], a[184:187], v[100:103]
  s_add_u32 m0, s27, 40960
  v_mfma_f32_16x16x32_bf16 v[104:107], a[40:43], a[184:187], v[104:107]
  v_mfma_f32_16x16x32_bf16 v[108:111], a[44:47], a[184:187], v[108:111]
  s_add_u32 s28, s56, 102400
  s_waitcnt lgkmcnt(3)
  v_mfma_f32_16x16x32_bf16 v[80:83], a[48:51], a[188:191], v[80:83]
  ds_read_b128 a[180:183], v190 offset:28672
  v_mfma_f32_16x16x32_bf16 v[84:87], a[52:55], a[188:191], v[84:87]
  buffer_load_dwordx4 v186, s[4:7], s28 offen  lds
  v_mfma_f32_16x16x32_bf16 v[88:91], a[56:59], a[188:191], v[88:91]
  v_mfma_f32_16x16x32_bf16 v[92:95], a[60:63], a[188:191], v[92:95]
  ds_read_b64_tr_b16 a[118:119], v196 offset:8704
  s_waitcnt lgkmcnt(2)
  v_mfma_f32_16x16x32_bf16 v[64:67], a[64:67], a[176:179], v[64:67]
  ds_read_b128 a[184:187], v191 offset:20480
  v_mfma_f32_16x16x32_bf16 v[68:71], a[68:71], a[176:179], v[68:71]
  ds_read_b64_tr_b16 a[120:121], v197 offset:0
  v_mfma_f32_16x16x32_bf16 v[72:75], a[72:75], a[176:179], v[72:75]
  v_mfma_f32_16x16x32_bf16 v[76:79], a[76:79], a[176:179], v[76:79]
  ds_read_b64_tr_b16 a[122:123], v197 offset:512
  s_waitcnt lgkmcnt(4)
  v_mfma_f32_16x16x32_bf16 v[48:51], a[80:83], a[180:183], v[48:51]
  ds_read_b128 a[188:191], v191 offset:12288
  v_mfma_f32_16x16x32_bf16 v[52:55], a[84:87], a[180:183], v[52:55]
  s_add_u32 m0, s27, 77824
  v_mfma_f32_16x16x32_bf16 v[56:59], a[88:91], a[180:183], v[56:59]
  v_cndmask_b32 v176, v176, v181, s[68:69]
  v_mfma_f32_16x16x32_bf16 v[60:63], a[92:95], a[180:183], v[60:63]
  s_add_u32 s28, s55, 20480
  s_waitcnt lgkmcnt(3)
  v_mfma_f32_16x16x32_bf16 v[32:35], a[96:99], a[184:187], v[32:35]
  v_cndmask_b32 v177, v177, v181, s[68:69]
  ds_read_b128 a[176:179], v192 offset:36864
  v_mfma_f32_16x16x32_bf16 v[36:39], a[100:103], a[184:187], v[36:39]
  buffer_load_dwordx4 v186, s[4:7], s28 offen  lds
  v_mfma_f32_16x16x32_bf16 v[40:43], a[104:107], a[184:187], v[40:43]
  v_cndmask_b32 v178, v178, v181, s[68:69]
  v_mfma_f32_16x16x32_bf16 v[44:47], a[108:111], a[184:187], v[44:47]
  ds_read_b64_tr_b16 a[124:125], v197 offset:8192
  s_waitcnt lgkmcnt(2)
  v_mfma_f32_16x16x32_bf16 v[16:19], a[96:99], a[188:191], v[16:19]
  v_cndmask_b32 v179, v179, v181, s[68:69]
  ds_read_b128 a[180:183], v193 offset:28672
  v_mfma_f32_16x16x32_bf16 v[20:23], a[100:103], a[188:191], v[20:23]
  ds_read_b64_tr_b16 a[126:127], v197 offset:8704
  v_mfma_f32_16x16x32_bf16 v[24:27], a[104:107], a[188:191], v[24:27]
  v_mfma_f32_16x16x32_bf16 v[28:31], a[108:111], a[188:191], v[28:31]
  v_mfma_f32_16x16x32_bf16 v[0:3], a[96:99], v[176:179], v[0:3]
  v_mfma_f32_16x16x32_bf16 v[4:7], a[100:103], v[176:179], v[4:7]
  v_mfma_f32_16x16x32_bf16 v[8:11], a[104:107], v[176:179], v[8:11]
  v_mfma_f32_16x16x32_bf16 v[12:15], a[108:111], v[176:179], v[12:15]
  s_waitcnt vmcnt(13)
  s_waitcnt lgkmcnt(0)
  s_barrier
  s_add_u32 m0, s27, 49152
  v_mfma_f32_16x16x32_bf16 v[160:163], a[128:131], a[176:179], v[160:163]
  ds_read_b128 v[176:179], v188 offset:0
  ds_read_b128 a[184:187], v194 offset:20480
  v_mfma_f32_16x16x32_bf16 v[164:167], a[132:135], a[176:179], v[164:167]
  s_add_u32 s28, s56, 81920
  v_mfma_f32_16x16x32_bf16 v[168:171], a[136:139], a[176:179], v[168:171]
  buffer_load_dwordx4 v186, s[4:7], s28 offen  lds
  v_mfma_f32_16x16x32_bf16 v[172:175], a[140:143], a[176:179], v[172:175]
  ds_read_b64_tr_b16 a[128:129], v196 offset:16384
  v_mfma_f32_16x16x32_bf16 v[144:147], a[0:3], a[180:183], v[144:147]
  ds_read_b128 a[188:191], v195 offset:12288
  v_mfma_f32_16x16x32_bf16 v[148:151], a[4:7], a[180:183], v[148:151]
  ds_read_b64_tr_b16 a[130:131], v196 offset:16896
  v_mfma_f32_16x16x32_bf16 v[152:155], a[8:11], a[180:183], v[152:155]
  ds_read_b64_tr_b16 a[132:133], v196 offset:24576
  v_mfma_f32_16x16x32_bf16 v[156:159], a[12:15], a[180:183], v[156:159]
  s_add_u32 m0, s27, 86016
  s_waitcnt lgkmcnt(4)
  v_mfma_f32_16x16x32_bf16 v[128:131], a[16:19], a[184:187], v[128:131]
  ds_read_b128 a[176:179], v192 offset:8192
  v_mfma_f32_16x16x32_bf16 v[132:135], a[20:23], a[184:187], v[132:135]
  s_add_u32 s28, s55, 0
  v_mfma_f32_16x16x32_bf16 v[136:139], a[24:27], a[184:187], v[136:139]
  buffer_load_dwordx4 v186, s[4:7], s28 offen  lds
  v_mfma_f32_16x16x32_bf16 v[140:143], a[28:31], a[184:187], v[140:143]
  s_waitcnt lgkmcnt(3)
  v_mfma_f32_16x16x32_bf16 v[112:115], a[32:35], a[188:191], v[112:115]
  ds_read_b128 a[180:183], v193 offset:0
  v_mfma_f32_16x16x32_bf16 v[116:119], a[36:39], a[188:191], v[116:119]
  ds_read_b64_tr_b16 a[134:135], v196 offset:25088
  v_mfma_f32_16x16x32_bf16 v[120:123], a[40:43], a[188:191], v[120:123]
  ds_read_b64_tr_b16 a[136:137], v197 offset:16384
  v_mfma_f32_16x16x32_bf16 v[124:127], a[44:47], a[188:191], v[124:127]
  ds_read_b64_tr_b16 a[138:139], v197 offset:16896
  s_waitcnt lgkmcnt(4)
  v_mfma_f32_16x16x32_bf16 v[96:99], a[48:51], a[176:179], v[96:99]
  ds_read_b128 a[184:187], v190 offset:36864
  v_mfma_f32_16x16x32_bf16 v[100:103], a[52:55], a[176:179], v[100:103]
  ds_read_b64_tr_b16 a[140:141], v197 offset:24576
  v_mfma_f32_16x16x32_bf16 v[104:107], a[56:59], a[176:179], v[104:107]
  ds_read_b64_tr_b16 a[142:143], v197 offset:25088
  v_mfma_f32_16x16x32_bf16 v[108:111], a[60:63], a[176:179], v[108:111]
  v_lshrrev_b32 v223, 5, v244
  s_waitcnt lgkmcnt(6)
  v_mfma_f32_16x16x32_bf16 v[80:83], a[64:67], a[180:183], v[80:83]
  ds_read_b128 a[188:191], v191 offset:28672
  v_mfma_f32_16x16x32_bf16 v[84:87], a[68:71], a[180:183], v[84:87]
  v_mad_u32_u24 v225, v223, s98, v255
  v_mfma_f32_16x16x32_bf16 v[88:91], a[72:75], a[180:183], v[88:91]
  s_add_u32 m0, s27, 90112
  v_mfma_f32_16x16x32_bf16 v[92:95], a[76:79], a[180:183], v[92:95]
  buffer_load_dwordx4 v225, s[64:67], s90 offen lds
  s_waitcnt lgkmcnt(3)
  v_mfma_f32_16x16x32_bf16 v[64:67], a[80:83], a[184:187], v[64:67]
  ds_read_b128 a[176:179], v188 offset:16384
  v_mfma_f32_16x16x32_bf16 v[68:71], a[84:87], a[184:187], v[68:71]
  v_mad_u32_u24 v226, v223, s99, v255
  v_mfma_f32_16x16x32_bf16 v[72:75], a[88:91], a[184:187], v[72:75]
  s_add_u32 m0, s27, 94208
  v_mfma_f32_16x16x32_bf16 v[76:79], a[92:95], a[184:187], v[76:79]
  s_waitcnt lgkmcnt(1)
  v_mfma_f32_16x16x32_bf16 v[48:51], a[96:99], a[188:191], v[48:51]
  ds_read_b128 a[180:183], v188 offset:8192
  v_mfma_f32_16x16x32_bf16 v[52:55], a[100:103], a[188:191], v[52:55]
  buffer_load_dwordx4 v226, s[64:67], s91 offen lds
  v_mad_u32_u24 v227, v223, s100, v255
  v_mfma_f32_16x16x32_bf16 v[56:59], a[104:107], a[188:191], v[56:59]
  v_cndmask_b32 v176, v176, v181, s[68:69]
  v_mfma_f32_16x16x32_bf16 v[60:63], a[108:111], a[188:191], v[60:63]
  s_add_u32 m0, s27, 98304
  s_waitcnt lgkmcnt(1)
  v_mfma_f32_16x16x32_bf16 v[32:35], a[112:115], a[176:179], v[32:35]
  v_cndmask_b32 v177, v177, v181, s[68:69]
  ds_read_b128 a[184:187], v193 offset:36864
  v_mfma_f32_16x16x32_bf16 v[36:39], a[116:119], a[176:179], v[36:39]
  buffer_load_dwordx4 v227, s[64:67], s92 offen lds
  v_mfma_f32_16x16x32_bf16 v[40:43], a[120:123], a[176:179], v[40:43]
  v_cndmask_b32 v178, v178, v181, s[68:69]
  s_mov_b32 s23, 0
L_k1_kernel_poll:
  s_waitcnt vmcnt(11)
  v_cmp_eq_u32 vcc, 4, v221
  v_cmp_gt_u32 s[44:45], s35, v244
  s_nop 0
  s_or_b64 vcc, vcc, s[44:45]
  v_cmp_lt_u32 s[44:45], s36, v244
  s_nop 0
  s_or_b64 vcc, vcc, s[44:45]
  s_cmp_eq_u64 vcc, -1
  s_cbranch_scc1 L_k1_kernel_pollok
  s_add_u32 s23, s23, 1
  s_cmp_gt_u32 s23, 200000
  s_cbranch_scc1 L_k1_kernel_pollok
  buffer_load_dword v221, v220, s[16:19], 0 offen sc1
  s_waitcnt vmcnt(0)
  s_branch L_k1_kernel_poll
L_k1_kernel_pollok:
  v_mfma_f32_16x16x32_bf16 v[44:47], a[124:127], a[176:179], v[44:47]
  buffer_load_dwordx2 a[192:193], v202, s[12:15], s34 offen offset:1280 sc1
  s_waitcnt lgkmcnt(1)
  v_mfma_f32_16x16x32_bf16 v[16:19], a[112:115], a[180:183], v[16:19]
  v_cndmask_b32 v179, v179, v181, s[68:69]
  ds_read_b128 a[188:191], v194 offset:28672
  v_mfma_f32_16x16x32_bf16 v[20:23], a[116:119], a[180:183], v[20:23]
  buffer_load_dwordx2 a[194:195], v202, s[12:15], s34 offen offset:1152 sc1
  v_mfma_f32_16x16x32_bf16 v[24:27], a[120:123], a[180:183], v[24:27]
  buffer_load_dwordx2 a[196:197], v202, s[12:15], s34 offen offset:1024 sc1
  v_mfma_f32_16x16x32_bf16 v[28:31], a[124:127], a[180:183], v[28:31]
  v_mfma_f32_16x16x32_bf16 v[0:3], a[112:115], v[176:179], v[0:3]
  v_mfma_f32_16x16x32_bf16 v[4:7], a[116:119], v[176:179], v[4:7]
  v_mfma_f32_16x16x32_bf16 v[8:11], a[120:123], v[176:179], v[8:11]
  v_mfma_f32_16x16x32_bf16 v[12:15], a[124:127], v[176:179], v[12:15]
  s_barrier
  s_add_u32 m0, s27, 57344
  s_waitcnt lgkmcnt(1)
  v_mfma_f32_16x16x32_bf16 v[160:163], a[0:3], a[184:187], v[160:163]
  ds_read_b128 v[176:179], v189 offset:0
  ds_read_b128 a[176:179], v195 offset:20480
  v_mfma_f32_16x16x32_bf16 v[164:167], a[4:7], a[184:187], v[164:167]
  s_add_u32 s28, s56, 61440
  v_mfma_f32_16x16x32_bf16 v[168:171], a[8:11], a[184:187], v[168:171]
  buffer_load_dwordx4 v186, s[4:7], s28 offen  lds
  v_mfma_f32_16x16x32_bf16 v[172:175], a[12:15], a[184:187], v[172:175]
  ds_read_b64_tr_b16 a[0:1], v196 offset:32768
  s_waitcnt lgkmcnt(3)
  v_mfma_f32_16x16x32_bf16 v[144:147], a[16:19], a[188:191], v[144:147]
  ds_read_b128 a[180:183], v192 offset:16384
  ds_read_b64_tr_b16 a[2:3], v196 offset:33280
  v_mfma_f32_16x16x32_bf16 v[148:151], a[20:23], a[188:191], v[148:151]
  ds_read_b64_tr_b16 a[4:5], v196 offset:40960
  v_mfma_f32_16x16x32_bf16 v[152:155], a[24:27], a[188:191], v[152:155]
  ds_read_b64_tr_b16 a[6:7], v196 offset:41472
  v_mfma_f32_16x16x32_bf16 v[156:159], a[28:31], a[188:191], v[156:159]
  ds_read_b64_tr_b16 a[8:9], v197 offset:32768
  s_waitcnt lgkmcnt(6)
  v_mfma_f32_16x16x32_bf16 v[128:131], a[32:35], a[176:179], v[128:131]
  ds_read_b128 a[184:187], v193 offset:8192
  v_mfma_f32_16x16x32_bf16 v[132:135], a[36:39], a[176:179], v[132:135]
  ds_read_b64_tr_b16 a[10:11], v197 offset:33280
  v_mfma_f32_16x16x32_bf16 v[136:139], a[40:43], a[176:179], v[136:139]
  ds_read_b64_tr_b16 a[12:13], v197 offset:40960
  ds_read_b64_tr_b16 a[14:15], v197 offset:41472
  v_mfma_f32_16x16x32_bf16 v[140:143], a[44:47], a[176:179], v[140:143]
  v_mov_b32 v230, -1
  s_waitcnt lgkmcnt(8)
  v_mfma_f32_16x16x32_bf16 v[112:115], a[48:51], a[180:183], v[112:115]
  ds_read_b128 a[188:191], v194 offset:0
  v_mfma_f32_16x16x32_bf16 v[116:119], a[52:55], a[180:183], v[116:119]
  v_mov_b32 v231, -1
  v_mfma_f32_16x16x32_bf16 v[120:123], a[56:59], a[180:183], v[120:123]
  v_mov_b32 v232, -1
  v_mfma_f32_16x16x32_bf16 v[124:127], a[60:63], a[180:183], v[124:127]
  v_mov_b32 v233, -1
  s_waitcnt lgkmcnt(4)
  v_mfma_f32_16x16x32_bf16 v[96:99], a[64:67], a[184:187], v[96:99]
  ds_read_b128 a[176:179], v191 offset:36864
  v_mfma_f32_16x16x32_bf16 v[100:103], a[68:71], a[184:187], v[100:103]
  s_mul_i32 s22, s2, 3072
  v_mfma_f32_16x16x32_bf16 v[104:107], a[72:75], a[184:187], v[104:107]
  s_add_u32 s22, s22, 23134208
  s_lshl_b32 s23, s20, 10
  v_mfma_f32_16x16x32_bf16 v[108:111], a[76:79], a[184:187], v[108:111]
  s_waitcnt lgkmcnt(1)
  v_mfma_f32_16x16x32_bf16 v[80:83], a[80:83], a[188:191], v[80:83]
  ds_read_b128 a[180:183], v188 offset:24576
  v_mfma_f32_16x16x32_bf16 v[84:87], a[84:87], a[188:191], v[84:87]
  s_add_u32 s22, s22, s23
  v_mfma_f32_16x16x32_bf16 v[88:91], a[88:91], a[188:191], v[88:91]
  s_cmp_eq_u32 s20, 3
  s_cselect_b32 s22, 1073741824, s22
  v_mfma_f32_16x16x32_bf16 v[92:95], a[92:95], a[188:191], v[92:95]
  v_lshlrev_b32 v234, 4, v244
  s_waitcnt lgkmcnt(1)
  v_mfma_f32_16x16x32_bf16 v[64:67], a[96:99], a[176:179], v[64:67]
  ds_read_b128 a[184:187], v189 offset:16384
  v_mfma_f32_16x16x32_bf16 v[68:71], a[100:103], a[176:179], v[68:71]
  buffer_store_dwordx4 v[230:233], v234, s[12:15], s22 offen sc1
  v_mfma_f32_16x16x32_bf16 v[72:75], a[104:107], a[176:179], v[72:75]
  s_lshl_b32 s22, s2, 2
  v_mfma_f32_16x16x32_bf16 v[76:79], a[108:111], a[176:179], v[76:79]
  s_add_u32 s22, s22, s20
  s_waitcnt lgkmcnt(1)
  v_mfma_f32_16x16x32_bf16 v[48:51], a[112:115], a[180:183], v[48:51]
  ds_read_b128 a[188:191], v189 offset:8192
  v_mfma_f32_16x16x32_bf16 v[52:55], a[116:119], a[180:183], v[52:55]
  s_lshl_b32 s22, s22, 6
  s_add_u32 s22, s22, 24182784
  v_mfma_f32_16x16x32_bf16 v[56:59], a[120:123], a[180:183], v[56:59]
  v_cndmask_b32 v176, v176, v181, s[68:69]
  v_mov_b32 v235, 0
  v_mfma_f32_16x16x32_bf16 v[60:63], a[124:127], a[180:183], v[60:63]
  v_mov_b32 v236, 1073741824
  s_waitcnt lgkmcnt(1)
  v_mfma_f32_16x16x32_bf16 v[32:35], a[128:131], a[184:187], v[32:35]
  v_cndmask_b32 v177, v177, v181, s[68:69]
  ds_read_b128 a[176:179], v194 offset:36864
  v_mfma_f32_16x16x32_bf16 v[36:39], a[132:135], a[184:187], v[36:39]
  v_cmp_eq_u32 vcc, 0, v244
  v_mfma_f32_16x16x32_bf16 v[40:43], a[136:139], a[184:187], v[40:43]
  v_cndmask_b32 v178, v178, v181, s[68:69]
  v_cndmask_b32 v236, v236, v235, vcc
  v_mfma_f32_16x16x32_bf16 v[44:47], a[140:143], a[184:187], v[44:47]
  buffer_store_dword v235, v236, s[12:15], s22 offen sc1
  s_waitcnt lgkmcnt(1)
  v_mfma_f32_16x16x32_bf16 v[16:19], a[128:131], a[188:191], v[16:19]
  v_cndmask_b32 v179, v179, v181, s[68:69]
  ds_read_b128 a[180:183], v195 offset:28672
  v_mfma_f32_16x16x32_bf16 v[20:23], a[132:135], a[188:191], v[20:23]
  buffer_load_dwordx2 a[198:199], v202, s[12:15], s34 offen offset:896 sc1
  v_mfma_f32_16x16x32_bf16 v[24:27], a[136:139], a[188:191], v[24:27]
  buffer_load_dwordx2 a[200:201], v202, s[12:15], s34 offen offset:768 sc1
  buffer_load_dwordx2 a[202:203], v202, s[12:15], s34 offen offset:640 sc1
  v_mfma_f32_16x16x32_bf16 v[28:31], a[140:143], a[188:191], v[28:31]
  v_mfma_f32_16x16x32_bf16 v[0:3], a[128:131], v[176:179], v[0:3]
  v_mfma_f32_16x16x32_bf16 v[4:7], a[132:135], v[176:179], v[4:7]
  v_mfma_f32_16x16x32_bf16 v[8:11], a[136:139], v[176:179], v[8:11]
  v_mfma_f32_16x16x32_bf16 v[12:15], a[140:143], v[176:179], v[12:15]
  s_waitcnt vmcnt(14)
  s_barrier
  s_add_u32 m0, s27, 65536
  s_waitcnt lgkmcnt(1)
  v_mfma_f32_16x16x32_bf16 v[160:163], a[16:19], a[176:179], v[160:163]
  ds_read_b128 v[176:179], v190 offset:0
  ds_read_b128 a[184:187], v192 offset:24576
  v_mfma_f32_16x16x32_bf16 v[164:167], a[20:23], a[176:179], v[164:167]
  s_add_u32 s28, s56, 40960
  v_mfma_f32_16x16x32_bf16 v[168:171], a[24:27], a[176:179], v[168:171]
  buffer_load_dwordx4 v186, s[4:7], s28 offen  lds
  v_mfma_f32_16x16x32_bf16 v[172:175], a[28:31], a[176:179], v[172:175]
  ds_read_b64_tr_b16 a[16:17], v196 offset:49152
  s_waitcnt lgkmcnt(3)
  v_mfma_f32_16x16x32_bf16 v[144:147], a[32:35], a[180:183], v[144:147]
  ds_read_b128 a[188:191], v193 offset:16384
  ds_read_b64_tr_b16 a[18:19], v196 offset:49664
  v_mfma_f32_16x16x32_bf16 v[148:151], a[36:39], a[180:183], v[148:151]
  ds_read_b64_tr_b16 a[20:21], v196 offset:57344
  v_mfma_f32_16x16x32_bf16 v[152:155], a[40:43], a[180:183], v[152:155]
  ds_read_b64_tr_b16 a[22:23], v196 offset:57856
  v_mfma_f32_16x16x32_bf16 v[156:159], a[44:47], a[180:183], v[156:159]
  ds_read_b64_tr_b16 a[24:25], v197 offset:49152
  s_waitcnt lgkmcnt(6)
  v_mfma_f32_16x16x32_bf16 v[128:131], a[48:51], a[184:187], v[128:131]
  ds_read_b128 a[176:179], v194 offset:8192
  v_mfma_f32_16x16x32_bf16 v[132:135], a[52:55], a[184:187], v[132:135]
  ds_read_b64_tr_b16 a[26:27], v197 offset:49664
  v_mfma_f32_16x16x32_bf16 v[136:139], a[56:59], a[184:187], v[136:139]
  ds_read_b64_tr_b16 a[28:29], v197 offset:57344
  v_mfma_f32_16x16x32_bf16 v[140:143], a[60:63], a[184:187], v[140:143]
  ds_read_b64_tr_b16 a[30:31], v197 offset:57856
  s_waitcnt lgkmcnt(8)
  v_mfma_f32_16x16x32_bf16 v[112:115], a[64:67], a[188:191], v[112:115]
  ds_read_b128 a[180:183], v195 offset:0
  v_mfma_f32_16x16x32_bf16 v[116:119], a[68:71], a[188:191], v[116:119]
  s_lshl_b32 s22, s20, 12
  v_mfma_f32_16x16x32_bf16 v[120:123], a[72:75], a[188:191], v[120:123]
  s_add_u32 s22, s22, 106496
  v_mfma_f32_16x16x32_bf16 v[124:127], a[76:79], a[188:191], v[124:127]
  v_lshlrev_b32 v205, 4, v244
  s_waitcnt lgkmcnt(4)
  v_mfma_f32_16x16x32_bf16 v[96:99], a[80:83], a[176:179], v[96:99]
  ds_read_b128 a[184:187], v188 offset:32768
  v_mfma_f32_16x16x32_bf16 v[100:103], a[84:87], a[176:179], v[100:103]
  v_add_u32 v205, s22, v205
  v_mfma_f32_16x16x32_bf16 v[104:107], a[88:91], a[176:179], v[104:107]
  v_lshrrev_b32 v206, 2, v245
  v_lshlrev_b32 v206, 8, v206
  v_mfma_f32_16x16x32_bf16 v[108:111], a[92:95], a[176:179], v[108:111]
  s_waitcnt lgkmcnt(1)
  v_mfma_f32_16x16x32_bf16 v[80:83], a[96:99], a[180:183], v[80:83]
  ds_read_b128 a[188:191], v189 offset:24576
  v_mfma_f32_16x16x32_bf16 v[84:87], a[100:103], a[180:183], v[84:87]
  v_lshl_add_u32 v206, v246, 10, v206
  v_mfma_f32_16x16x32_bf16 v[88:91], a[104:107], a[180:183], v[88:91]
  v_and_b32 v207, 3, v245
  v_lshl_add_u32 v206, v207, 2, v206
  v_mfma_f32_16x16x32_bf16 v[92:95], a[108:111], a[180:183], v[92:95]
  v_add_u32 v206, s22, v206
  s_waitcnt lgkmcnt(1)
  v_mfma_f32_16x16x32_bf16 v[64:67], a[112:115], a[184:187], v[64:67]
  ds_read_b128 a[176:179], v190 offset:16384
  v_mfma_f32_16x16x32_bf16 v[68:71], a[116:119], a[184:187], v[68:71]
  s_lshr_b32 s24, s2, 3
  v_mfma_f32_16x16x32_bf16 v[72:75], a[120:123], a[184:187], v[72:75]
  s_mul_i32 s24, s24, 640
  v_mfma_f32_16x16x32_bf16 v[76:79], a[124:127], a[184:187], v[76:79]
  s_add_u32 s24, s24, L_k2_code-L_k1_kernel_pc
  s_waitcnt lgkmcnt(1)
  v_mfma_f32_16x16x32_bf16 v[48:51], a[128:131], a[188:191], v[48:51]
  ds_read_b128 a[180:183], v190 offset:8192
  v_mfma_f32_16x16x32_bf16 v[52:55], a[132:135], a[188:191], v[52:55]
  v_min_u32 v182, 4, v244
  v_mfma_f32_16x16x32_bf16 v[56:59], a[136:139], a[188:191], v[56:59]
  v_cndmask_b32 v176, v176, v181, s[68:69]
  v_lshlrev_b32 v182, 7, v182
  v_mfma_f32_16x16x32_bf16 v[60:63], a[140:143], a[188:191], v[60:63]
  v_add_u32 v182, s24, v182
  s_waitcnt lgkmcnt(1)
  v_mfma_f32_16x16x32_bf16 v[32:35], a[0:3], a[176:179], v[32:35]
  v_cndmask_b32 v177, v177, v181, s[68:69]
  ds_read_b128 a[184:187], v195 offset:36864
  v_mfma_f32_16x16x32_bf16 v[36:39], a[4:7], a[176:179], v[36:39]
  s_mov_b32 s24, L_code_end-L_k1_kernel_pc-4
  v_min_u32 v182, s24, v182
  v_mfma_f32_16x16x32_bf16 v[40:43], a[8:11], a[176:179], v[40:43]
  v_cndmask_b32 v178, v178, v181, s[68:69]
  v_mfma_f32_16x16x32_bf16 v[44:47], a[12:15], a[176:179], v[44:47]
  global_load_dword v183, v182, s[46:47]
  s_waitcnt lgkmcnt(1)
  v_mfma_f32_16x16x32_bf16 v[16:19], a[0:3], a[180:183], v[16:19]
  v_cndmask_b32 v179, v179, v181, s[68:69]
  ds_read_b128 a[188:191], v192 offset:32768
  v_mfma_f32_16x16x32_bf16 v[20:23], a[4:7], a[180:183], v[20:23]
  buffer_load_dwordx2 a[204:205], v202, s[12:15], s34 offen offset:512 sc1
  v_mfma_f32_16x16x32_bf16 v[24:27], a[8:11], a[180:183], v[24:27]
  buffer_load_dwordx2 a[206:207], v202, s[12:15], s34 offen offset:384 sc1
  buffer_load_dwordx2 a[208:209], v202, s[12:15], s34 offen offset:256 sc1
  v_mfma_f32_16x16x32_bf16 v[28:31], a[12:15], a[180:183], v[28:31]
  v_mfma_f32_16x16x32_bf16 v[0:3], a[0:3], v[176:179], v[0:3]
  v_mfma_f32_16x16x32_bf16 v[4:7], a[4:7], v[176:179], v[4:7]
  v_mfma_f32_16x16x32_bf16 v[8:11], a[8:11], v[176:179], v[8:11]
  v_mfma_f32_16x16x32_bf16 v[12:15], a[12:15], v[176:179], v[12:15]
  s_waitcnt vmcnt(14)
  s_barrier
  s_add_u32 m0, s27, 73728
  s_waitcnt lgkmcnt(1)
  v_mfma_f32_16x16x32_bf16 v[160:163], a[32:35], a[184:187], v[160:163]
  ds_read_b128 v[176:179], v191 offset:0
  ds_read_b128 a[176:179], v193 offset:24576
  v_mfma_f32_16x16x32_bf16 v[164:167], a[36:39], a[184:187], v[164:167]
  s_add_u32 s28, s56, 20480
  v_mfma_f32_16x16x32_bf16 v[168:171], a[40:43], a[184:187], v[168:171]
  v_mfma_f32_16x16x32_bf16 v[172:175], a[44:47], a[184:187], v[172:175]
  buffer_load_dwordx4 v186, s[4:7], s28 offen  lds
  s_waitcnt lgkmcnt(2)
  v_mfma_f32_16x16x32_bf16 v[144:147], a[48:51], a[188:191], v[144:147]
  ds_read_b128 a[180:183], v194 offset:16384
  v_mfma_f32_16x16x32_bf16 v[148:151], a[52:55], a[188:191], v[148:151]
  v_mfma_f32_16x16x32_bf16 v[152:155], a[56:59], a[188:191], v[152:155]
  v_add_u32 v222, s71, v250
  v_mfma_f32_16x16x32_bf16 v[156:159], a[60:63], a[188:191], v[156:159]
  s_waitcnt lgkmcnt(1)
  v_mfma_f32_16x16x32_bf16 v[128:131], a[64:67], a[176:179], v[128:131]
  ds_read_b128 a[184:187], v195 offset:8192
  v_mfma_f32_16x16x32_bf16 v[132:135], a[68:71], a[176:179], v[132:135]
  ds_read_b64_tr_b16 a[216:217], v250
  v_mfma_f32_16x16x32_bf16 v[136:139], a[72:75], a[176:179], v[136:139]
  v_mfma_f32_16x16x32_bf16 v[140:143], a[76:79], a[176:179], v[140:143]
  ds_read_b64_tr_b16 a[218:219], v222
  s_waitcnt lgkmcnt(3)
  v_mfma_f32_16x16x32_bf16 v[112:115], a[80:83], a[180:183], v[112:115]
  ds_read_b128 a[188:191], v188 offset:40960
  v_mfma_f32_16x16x32_bf16 v[116:119], a[84:87], a[180:183], v[116:119]
  v_add_u32 v222, s71, v251
  v_mfma_f32_16x16x32_bf16 v[120:123], a[88:91], a[180:183], v[120:123]
  v_mfma_f32_16x16x32_bf16 v[124:127], a[92:95], a[180:183], v[124:127]
  ds_read_b64_tr_b16 a[220:221], v251
  s_waitcnt lgkmcnt(4)
  v_mfma_f32_16x16x32_bf16 v[96:99], a[96:99], a[184:187], v[96:99]
  ds_read_b128 a[176:179], v189 offset:32768
  v_mfma_f32_16x16x32_bf16 v[100:103], a[100:103], a[184:187], v[100:103]
  v_mfma_f32_16x16x32_bf16 v[104:107], a[104:107], a[184:187], v[104:107]
  ds_read_b64_tr_b16 a[222:223], v222
  v_mfma_f32_16x16x32_bf16 v[108:111], a[108:111], a[184:187], v[108:111]
  s_waitcnt lgkmcnt(3)
  v_mfma_f32_16x16x32_bf16 v[80:83], a[112:115], a[188:191], v[80:83]
  ds_read_b128 a[180:183], v190 offset:24576
  v_mfma_f32_16x16x32_bf16 v[84:87], a[116:119], a[188:191], v[84:87]
  v_add_u32 v222, s71, v252
  v_mfma_f32_16x16x32_bf16 v[88:91], a[120:123], a[188:191], v[88:91]
  v_mfma_f32_16x16x32_bf16 v[92:95], a[124:127], a[188:191], v[92:95]
  ds_read_b64_tr_b16 a[224:225], v252
  s_waitcnt lgkmcnt(3)
  v_mfma_f32_16x16x32_bf16 v[64:67], a[128:131], a[176:179], v[64:67]
  ds_read_b128 a[184:187], v191 offset:16384
  v_mfma_f32_16x16x32_bf16 v[68:71], a[132:135], a[176:179], v[68:71]
  ds_read_b64_tr_b16 a[226:227], v222
  v_mfma_f32_16x16x32_bf16 v[72:75], a[136:139], a[176:179], v[72:75]
  v_mfma_f32_16x16x32_bf16 v[76:79], a[140:143], a[176:179], v[76:79]
  buffer_store_dwordx4 a[216:219], v254, s[12:15], s94 offen sc1
  s_waitcnt lgkmcnt(3)
  v_mfma_f32_16x16x32_bf16 v[48:51], a[0:3], a[180:183], v[48:51]
  ds_read_b128 a[188:191], v191 offset:8192
  v_mfma_f32_16x16x32_bf16 v[52:55], a[4:7], a[180:183], v[52:55]
  v_mfma_f32_16x16x32_bf16 v[56:59], a[8:11], a[180:183], v[56:59]
  v_cndmask_b32 v176, v176, v181, s[68:69]
  buffer_store_dwordx4 a[220:223], v254, s[12:15], s95 offen sc1
  v_mfma_f32_16x16x32_bf16 v[60:63], a[12:15], a[180:183], v[60:63]
  s_waitcnt lgkmcnt(2)
  v_mfma_f32_16x16x32_bf16 v[32:35], a[16:19], a[184:187], v[32:35]
  v_cndmask_b32 v177, v177, v181, s[68:69]
  ds_read_b128 a[176:179], v192 offset:40960
  v_mfma_f32_16x16x32_bf16 v[36:39], a[20:23], a[184:187], v[36:39]
  s_waitcnt lgkmcnt(2)
  buffer_store_dwordx4 a[224:227], v254, s[12:15], s96 offen sc1
  v_mfma_f32_16x16x32_bf16 v[40:43], a[24:27], a[184:187], v[40:43]
  v_cndmask_b32 v178, v178, v181, s[68:69]
  v_mfma_f32_16x16x32_bf16 v[44:47], a[28:31], a[184:187], v[44:47]
  buffer_load_dwordx2 a[210:211], v202, s[12:15], s34 offen offset:128 sc1
  s_waitcnt lgkmcnt(1)
  v_mfma_f32_16x16x32_bf16 v[16:19], a[16:19], a[188:191], v[16:19]
  v_cndmask_b32 v179, v179, v181, s[68:69]
  ds_read_b128 a[180:183], v193 offset:32768
  v_mfma_f32_16x16x32_bf16 v[20:23], a[20:23], a[188:191], v[20:23]
  buffer_load_dwordx2 a[212:213], v202, s[12:15], s34 offen offset:0 sc1
  v_mfma_f32_16x16x32_bf16 v[24:27], a[24:27], a[188:191], v[24:27]
  v_mfma_f32_16x16x32_bf16 v[28:31], a[28:31], a[188:191], v[28:31]
  v_mfma_f32_16x16x32_bf16 v[0:3], a[16:19], v[176:179], v[0:3]
  v_mfma_f32_16x16x32_bf16 v[4:7], a[20:23], v[176:179], v[4:7]
  v_mfma_f32_16x16x32_bf16 v[8:11], a[24:27], v[176:179], v[8:11]
  v_mfma_f32_16x16x32_bf16 v[12:15], a[28:31], v[176:179], v[12:15]
  s_waitcnt vmcnt(10)
  s_barrier
  s_cmp_eq_u32 s30, 0
  s_cbranch_scc0 L_k1_kernel_tailP
  s_add_u32 m0, s27, 81920
  s_waitcnt lgkmcnt(1)
  v_mfma_f32_16x16x32_bf16 v[160:163], a[48:51], a[176:179], v[160:163]
  ds_read_b128 a[184:187], v194 offset:24576
  s_add_u32 s28, s56, 0
  v_mfma_f32_16x16x32_bf16 v[164:167], a[52:55], a[176:179], v[164:167]
  ds_write_b128 v205, v[0:3] offset:0
  ds_write_b128 v205, v[4:7] offset:1024
  v_mfma_f32_16x16x32_bf16 v[168:171], a[56:59], a[176:179], v[168:171]
  ds_write_b128 v205, v[8:11] offset:2048
  ds_write_b128 v205, v[12:15] offset:3072
  v_mfma_f32_16x16x32_bf16 v[172:175], a[60:63], a[176:179], v[172:175]
  ds_read_b32 v207, v206 offset:240
  s_waitcnt lgkmcnt(6)
  v_mfma_f32_16x16x32_bf16 v[144:147], a[64:67], a[180:183], v[144:147]
  ds_read_b128 a[188:191], v195 offset:16384
  buffer_load_dwordx4 v186, s[4:7], s28 offen  lds
  v_mfma_f32_16x16x32_bf16 v[148:151], a[68:71], a[180:183], v[148:151]
  v_accvgpr_read_b32 v208, a193
  v_mfma_f32_16x16x32_bf16 v[152:155], a[72:75], a[180:183], v[152:155]
  v_mul_f32 v208, v208, v208
  v_accvgpr_read_b32 v209, a195
  v_mfma_f32_16x16x32_bf16 v[156:159], a[76:79], a[180:183], v[156:159]
  v_mul_f32 v209, v209, v209
  s_waitcnt lgkmcnt(6)
  v_mfma_f32_16x16x32_bf16 v[128:131], a[80:83], a[184:187], v[128:131]
  ds_read_b128 a[176:179], v192 offset:4096
  s_waitcnt lgkmcnt(2)
  v_xor_b32 v204, 0x80000000, v207
  v_mfma_f32_16x16x32_bf16 v[132:135], a[84:87], a[184:187], v[132:135]
  s_nop 0
  v_mfma_f32_16x16x1_4b_f32 v[0:15], v204, a192, v[0:15]
  v_accvgpr_read_b32 v210, a197
  v_mfma_f32_16x16x32_bf16 v[136:139], a[88:91], a[184:187], v[136:139]
  v_mfma_f32_16x16x1_4b_f32 v[16:31], v204, a194, v[16:31]
  v_mul_f32 v210, v210, v210
  v_accvgpr_read_b32 v211, a199
  v_mul_f32 v211, v211, v211
  v_accvgpr_read_b32 v212, a201
  v_mfma_f32_16x16x32_bf16 v[140:143], a[92:95], a[184:187], v[140:143]
  v_mfma_f32_16x16x1_4b_f32 v[32:47], v204, a196, v[32:47]
  v_mul_f32 v212, v212, v212
  v_accvgpr_read_b32 v213, a203
  v_mul_f32 v213, v213, v213
  s_waitcnt lgkmcnt(1)
  v_mfma_f32_16x16x32_bf16 v[112:115], a[96:99], a[188:191], v[112:115]
  ds_read_b128 a[180:183], v189 offset:40960
  s_waitcnt vmcnt(9)
  v_accvgpr_read_b32 v214, a205
  v_mfma_f32_16x16x32_bf16 v[116:119], a[100:103], a[188:191], v[116:119]
  v_mul_f32 v214, v214, v214
  v_mfma_f32_16x16x32_bf16 v[120:123], a[104:107], a[188:191], v[120:123]
  s_waitcnt vmcnt(8)
  v_accvgpr_read_b32 v215, a207
  v_mul_f32 v215, v215, v215
  v_mfma_f32_16x16x32_bf16 v[124:127], a[108:111], a[188:191], v[124:127]
  s_waitcnt vmcnt(7)
  v_accvgpr_read_b32 v216, a209
  s_waitcnt lgkmcnt(1)
  v_mfma_f32_16x16x32_bf16 v[96:99], a[112:115], a[176:179], v[96:99]
  ds_read_b128 a[184:187], v190 offset:32768
  v_mul_f32 v216, v216, v216
  v_mfma_f32_16x16x32_bf16 v[100:103], a[116:119], a[176:179], v[100:103]
  v_mul_f32 v0, v0, v4
  v_mfma_f32_16x16x32_bf16 v[104:107], a[120:123], a[176:179], v[104:107]
  v_mul_f32 v1, v1, v5
  v_mul_f32 v2, v2, v6
  v_mfma_f32_16x16x32_bf16 v[108:111], a[124:127], a[176:179], v[108:111]
  v_mul_f32 v3, v3, v7
  s_waitcnt lgkmcnt(1)
  v_mfma_f32_16x16x32_bf16 v[80:83], a[128:131], a[180:183], v[80:83]
  ds_read_b128 a[188:191], v191 offset:24576
  v_mul_f32 v0, v0, v208
  v_mfma_f32_16x16x32_bf16 v[84:87], a[132:135], a[180:183], v[84:87]
  v_mul_f32 v1, v1, v208
  v_mfma_f32_16x16x32_bf16 v[88:91], a[136:139], a[180:183], v[88:91]
  v_mul_f32 v2, v2, v208
  v_mul_f32 v3, v3, v208
  v_mfma_f32_16x16x32_bf16 v[92:95], a[140:143], a[180:183], v[92:95]
  v_cvt_pk_bf16_f32 v220, v0, v1
  s_waitcnt lgkmcnt(1)
  v_mfma_f32_16x16x32_bf16 v[64:67], a[0:3], a[184:187], v[64:67]
  ds_read_b128 a[176:179], v193 offset:40960
  v_cvt_pk_bf16_f32 v221, v2, v3
  v_mfma_f32_16x16x32_bf16 v[68:71], a[4:7], a[184:187], v[68:71]
  v_mul_f32 v8, v8, v12
  v_mfma_f32_16x16x32_bf16 v[72:75], a[8:11], a[184:187], v[72:75]
  v_mul_f32 v9, v9, v13
  v_mul_f32 v10, v10, v14
  v_mfma_f32_16x16x32_bf16 v[76:79], a[12:15], a[184:187], v[76:79]
  v_mfma_f32_16x16x1_4b_f32 v[48:63], v204, a198, v[48:63]
  v_mul_f32 v11, v11, v15
  v_mul_f32 v8, v8, v208
  v_mul_f32 v9, v9, v208
  s_waitcnt lgkmcnt(1)
  v_mfma_f32_16x16x32_bf16 v[48:51], a[16:19], a[188:191], v[48:51]
  ds_read_b128 a[180:183], v194 offset:32768
  v_mul_f32 v10, v10, v208
  v_mfma_f32_16x16x32_bf16 v[52:55], a[20:23], a[188:191], v[52:55]
  v_mul_f32 v11, v11, v208
  v_mfma_f32_16x16x32_bf16 v[56:59], a[24:27], a[188:191], v[56:59]
  v_cvt_pk_bf16_f32 v222, v8, v9
  v_cvt_pk_bf16_f32 v223, v10, v11
  v_mfma_f32_16x16x32_bf16 v[60:63], a[28:31], a[188:191], v[60:63]
  s_waitcnt vmcnt(1)
  v_mfma_f32_16x16x1_4b_f32 v[160:175], v204, a212, v[160:175]
  buffer_store_dwordx4 v[220:223], v199, s[12:15], s80 offen sc1
  v_mul_f32 v16, v16, v20
  s_waitcnt lgkmcnt(1)
  v_mfma_f32_16x16x32_bf16 v[160:163], a[64:67], a[176:179], v[160:163]
  ds_read_b128 a[184:187], v195 offset:24576
  v_mfma_f32_16x16x32_bf16 v[164:167], a[68:71], a[176:179], v[164:167]
  v_mul_f32 v17, v17, v21
  v_mfma_f32_16x16x32_bf16 v[168:171], a[72:75], a[176:179], v[168:171]
  v_mul_f32 v18, v18, v22
  v_mul_f32 v19, v19, v23
  v_mfma_f32_16x16x32_bf16 v[172:175], a[76:79], a[176:179], v[172:175]
  v_mfma_f32_16x16x1_4b_f32 v[144:159], v204, a210, v[144:159]
  v_mul_f32 v16, v16, v209
  v_mul_f32 v17, v17, v209
  v_mul_f32 v18, v18, v209
  s_waitcnt lgkmcnt(1)
  v_mfma_f32_16x16x32_bf16 v[144:147], a[80:83], a[180:183], v[144:147]
  ds_read_b128 a[188:191], v192 offset:12288
  v_mul_f32 v19, v19, v209
  v_mfma_f32_16x16x32_bf16 v[148:151], a[84:87], a[180:183], v[148:151]
  v_cvt_pk_bf16_f32 v224, v16, v17
  v_mfma_f32_16x16x32_bf16 v[152:155], a[88:91], a[180:183], v[152:155]
  v_cvt_pk_bf16_f32 v225, v18, v19
  v_mul_f32 v24, v24, v28
  v_mfma_f32_16x16x32_bf16 v[156:159], a[92:95], a[180:183], v[156:159]
  v_mfma_f32_16x16x1_4b_f32 v[128:143], v204, a208, v[128:143]
  v_mul_f32 v25, v25, v29
  v_mul_f32 v26, v26, v30
  v_mul_f32 v27, v27, v31
  s_waitcnt lgkmcnt(1)
  v_mfma_f32_16x16x32_bf16 v[128:131], a[96:99], a[184:187], v[128:131]
  ds_read_b128 a[176:179], v193 offset:4096
  v_mul_f32 v24, v24, v209
  v_mfma_f32_16x16x32_bf16 v[132:135], a[100:103], a[184:187], v[132:135]
  v_mul_f32 v25, v25, v209
  v_mfma_f32_16x16x32_bf16 v[136:139], a[104:107], a[184:187], v[136:139]
  v_mul_f32 v26, v26, v209
  v_mul_f32 v27, v27, v209
  v_mfma_f32_16x16x32_bf16 v[140:143], a[108:111], a[184:187], v[140:143]
  v_mfma_f32_16x16x1_4b_f32 v[112:127], v204, a206, v[112:127]
  v_cvt_pk_bf16_f32 v226, v24, v25
  v_cvt_pk_bf16_f32 v227, v26, v27
  buffer_store_dwordx4 v[224:227], v198, s[12:15], s81 offen sc1
  s_waitcnt lgkmcnt(1)
  v_mfma_f32_16x16x32_bf16 v[112:115], a[112:115], a[188:191], v[112:115]
  ds_read_b128 a[180:183], v190 offset:40960
  v_mul_f32 v32, v32, v36
  v_mfma_f32_16x16x32_bf16 v[116:119], a[116:119], a[188:191], v[116:119]
  v_mul_f32 v33, v33, v37
  v_mfma_f32_16x16x32_bf16 v[120:123], a[120:123], a[188:191], v[120:123]
  v_mul_f32 v34, v34, v38
  v_mul_f32 v35, v35, v39
  v_mfma_f32_16x16x32_bf16 v[124:127], a[124:127], a[188:191], v[124:127]
  v_mfma_f32_16x16x1_4b_f32 v[96:111], v204, a204, v[96:111]
  v_mul_f32 v32, v32, v210
  v_mul_f32 v33, v33, v210
  v_mul_f32 v34, v34, v210
  s_waitcnt lgkmcnt(1)
  v_mfma_f32_16x16x32_bf16 v[96:99], a[128:131], a[176:179], v[96:99]
  ds_read_b128 a[184:187], v191 offset:32768
  v_mul_f32 v35, v35, v210
  v_mfma_f32_16x16x32_bf16 v[100:103], a[132:135], a[176:179], v[100:103]
  v_cvt_pk_bf16_f32 v220, v32, v33
  v_mfma_f32_16x16x32_bf16 v[104:107], a[136:139], a[176:179], v[104:107]
  v_cvt_pk_bf16_f32 v221, v34, v35
  v_mul_f32 v40, v40, v44
  v_mfma_f32_16x16x32_bf16 v[108:111], a[140:143], a[176:179], v[108:111]
  v_mfma_f32_16x16x1_4b_f32 v[80:95], v204, a202, v[80:95]
  v_mul_f32 v41, v41, v45
  v_mul_f32 v42, v42, v46
  v_mul_f32 v43, v43, v47
  s_waitcnt lgkmcnt(1)
  v_mfma_f32_16x16x32_bf16 v[80:83], a[0:3], a[180:183], v[80:83]
  ds_read_b128 a[188:191], v194 offset:40960
  v_mul_f32 v40, v40, v210
  v_mfma_f32_16x16x32_bf16 v[84:87], a[4:7], a[180:183], v[84:87]
  v_mul_f32 v41, v41, v210
  v_mfma_f32_16x16x32_bf16 v[88:91], a[8:11], a[180:183], v[88:91]
  v_mul_f32 v42, v42, v210
  v_mul_f32 v43, v43, v210
  v_mfma_f32_16x16x32_bf16 v[92:95], a[12:15], a[180:183], v[92:95]
  v_mfma_f32_16x16x1_4b_f32 v[64:79], v204, a200, v[64:79]
  v_cvt_pk_bf16_f32 v222, v40, v41
  v_cvt_pk_bf16_f32 v223, v42, v43
  buffer_store_dwordx4 v[220:223], v198, s[12:15], s82 offen sc1
  s_waitcnt lgkmcnt(1)
  v_mfma_f32_16x16x32_bf16 v[64:67], a[16:19], a[184:187], v[64:67]
  ds_read_b128 a[176:179], v195 offset:32768
  v_mul_f32 v48, v48, v52
  v_mfma_f32_16x16x32_bf16 v[68:71], a[20:23], a[184:187], v[68:71]
  v_mul_f32 v49, v49, v53
  v_mfma_f32_16x16x32_bf16 v[72:75], a[24:27], a[184:187], v[72:75]
  v_mul_f32 v50, v50, v54
  v_mul_f32 v51, v51, v55
  v_mfma_f32_16x16x32_bf16 v[76:79], a[28:31], a[184:187], v[76:79]
  s_waitcnt vmcnt(3)
  s_barrier
  v_accvgpr_read_b32 v218, a213
  s_waitcnt lgkmcnt(1)
  v_mfma_f32_16x16x32_bf16 v[160:163], a[80:83], a[188:191], v[160:163]
  ds_read_b128 a[180:183], v192 offset:20480
  v_mul_f32 v218, v218, v218
  v_mfma_f32_16x16x32_bf16 v[164:167], a[84:87], a[188:191], v[164:167]
  v_accvgpr_read_b32 v217, a211
  v_mfma_f32_16x16x32_bf16 v[168:171], a[88:91], a[188:191], v[168:171]
  v_mul_f32 v217, v217, v217
  v_mul_f32 v48, v48, v211
  v_mfma_f32_16x16x32_bf16 v[172:175], a[92:95], a[188:191], v[172:175]
  v_mul_f32 v49, v49, v211
  s_waitcnt lgkmcnt(1)
  v_mfma_f32_16x16x32_bf16 v[144:147], a[96:99], a[176:179], v[144:147]
  ds_read_b128 a[184:187], v193 offset:12288
  v_mul_f32 v50, v50, v211
  v_mfma_f32_16x16x32_bf16 v[148:151], a[100:103], a[176:179], v[148:151]
  v_mul_f32 v51, v51, v211
  v_mfma_f32_16x16x32_bf16 v[152:155], a[104:107], a[176:179], v[152:155]
  v_cvt_pk_bf16_f32 v224, v48, v49
  v_cvt_pk_bf16_f32 v225, v50, v51
  v_mfma_f32_16x16x32_bf16 v[156:159], a[108:111], a[176:179], v[156:159]
  v_mul_f32 v56, v56, v60
  s_waitcnt lgkmcnt(1)
  v_mfma_f32_16x16x32_bf16 v[128:131], a[112:115], a[180:183], v[128:131]
  ds_read_b128 a[188:191], v194 offset:4096
  v_mul_f32 v57, v57, v61
  v_mfma_f32_16x16x32_bf16 v[132:135], a[116:119], a[180:183], v[132:135]
  v_mul_f32 v58, v58, v62
  v_mfma_f32_16x16x32_bf16 v[136:139], a[120:123], a[180:183], v[136:139]
  v_mul_f32 v59, v59, v63
  v_mul_f32 v56, v56, v211
  v_mfma_f32_16x16x32_bf16 v[140:143], a[124:127], a[180:183], v[140:143]
  v_mul_f32 v57, v57, v211
  s_waitcnt lgkmcnt(1)
  v_mfma_f32_16x16x32_bf16 v[112:115], a[128:131], a[184:187], v[112:115]
  ds_read_b128 a[176:179], v191 offset:40960
  v_mul_f32 v58, v58, v211
  v_mfma_f32_16x16x32_bf16 v[116:119], a[132:135], a[184:187], v[116:119]
  v_mul_f32 v59, v59, v211
  v_mfma_f32_16x16x32_bf16 v[120:123], a[136:139], a[184:187], v[120:123]
  v_cvt_pk_bf16_f32 v226, v56, v57
  v_cvt_pk_bf16_f32 v227, v58, v59
  v_mfma_f32_16x16x32_bf16 v[124:127], a[140:143], a[184:187], v[124:127]
  buffer_store_dwordx4 v[224:227], v198, s[12:15], s83 offen sc1
  s_waitcnt lgkmcnt(1)
  v_mfma_f32_16x16x32_bf16 v[96:99], a[0:3], a[188:191], v[96:99]
  ds_read_b128 a[180:183], v195 offset:40960
  v_mul_f32 v64, v64, v68
  v_mfma_f32_16x16x32_bf16 v[100:103], a[4:7], a[188:191], v[100:103]
  v_mul_f32 v65, v65, v69
  v_mfma_f32_16x16x32_bf16 v[104:107], a[8:11], a[188:191], v[104:107]
  v_mul_f32 v66, v66, v70
  v_mul_f32 v67, v67, v71
  v_mfma_f32_16x16x32_bf16 v[108:111], a[12:15], a[188:191], v[108:111]
  v_mul_f32 v64, v64, v212
  s_waitcnt lgkmcnt(1)
  v_mfma_f32_16x16x32_bf16 v[80:83], a[16:19], a[176:179], v[80:83]
  ds_read_b128 a[184:187], v192 offset:28672
  v_mul_f32 v65, v65, v212
  v_mfma_f32_16x16x32_bf16 v[84:87], a[20:23], a[176:179], v[84:87]
  v_mul_f32 v66, v66, v212
  v_mfma_f32_16x16x32_bf16 v[88:91], a[24:27], a[176:179], v[88:91]
  v_mul_f32 v67, v67, v212
  v_cvt_pk_bf16_f32 v220, v64, v65
  v_mfma_f32_16x16x32_bf16 v[92:95], a[28:31], a[176:179], v[92:95]
  v_cvt_pk_bf16_f32 v221, v66, v67
  s_waitcnt lgkmcnt(1)
  v_mfma_f32_16x16x32_bf16 v[160:163], a[96:99], a[180:183], v[160:163]
  ds_read_b128 a[188:191], v193 offset:20480
  v_mul_f32 v72, v72, v76
  v_mfma_f32_16x16x32_bf16 v[164:167], a[100:103], a[180:183], v[164:167]
  v_mul_f32 v73, v73, v77
  v_mfma_f32_16x16x32_bf16 v[168:171], a[104:107], a[180:183], v[168:171]
  v_mul_f32 v74, v74, v78
  v_mul_f32 v75, v75, v79
  v_mfma_f32_16x16x32_bf16 v[172:175], a[108:111], a[180:183], v[172:175]
  v_mul_f32 v72, v72, v212
  s_waitcnt lgkmcnt(1)
  v_mfma_f32_16x16x32_bf16 v[144:147], a[112:115], a[184:187], v[144:147]
  ds_read_b128 a[176:179], v194 offset:12288
  v_mul_f32 v73, v73, v212
  v_mfma_f32_16x16x32_bf16 v[148:151], a[116:119], a[184:187], v[148:151]
  v_mul_f32 v74, v74, v212
  v_mfma_f32_16x16x32_bf16 v[152:155], a[120:123], a[184:187], v[152:155]
  v_mul_f32 v75, v75, v212
  v_cvt_pk_bf16_f32 v222, v72, v73
  v_mfma_f32_16x16x32_bf16 v[156:159], a[124:127], a[184:187], v[156:159]
  v_cvt_pk_bf16_f32 v223, v74, v75
  s_waitcnt lgkmcnt(1)
  v_mfma_f32_16x16x32_bf16 v[128:131], a[128:131], a[188:191], v[128:131]
  ds_read_b128 a[180:183], v195 offset:4096
  buffer_store_dwordx4 v[220:223], v198, s[12:15], s84 offen sc1
  v_mfma_f32_16x16x32_bf16 v[132:135], a[132:135], a[188:191], v[132:135]
  v_mul_f32 v80, v80, v84
  v_mfma_f32_16x16x32_bf16 v[136:139], a[136:139], a[188:191], v[136:139]
  v_mul_f32 v81, v81, v85
  v_mul_f32 v82, v82, v86
  v_mfma_f32_16x16x32_bf16 v[140:143], a[140:143], a[188:191], v[140:143]
  v_mul_f32 v83, v83, v87
  s_waitcnt lgkmcnt(1)
  v_mfma_f32_16x16x32_bf16 v[112:115], a[0:3], a[176:179], v[112:115]
  ds_read_b128 a[184:187], v192 offset:36864
  v_mul_f32 v80, v80, v213
  v_mfma_f32_16x16x32_bf16 v[116:119], a[4:7], a[176:179], v[116:119]
  v_mul_f32 v81, v81, v213
  v_mfma_f32_16x16x32_bf16 v[120:123], a[8:11], a[176:179], v[120:123]
  v_mul_f32 v82, v82, v213
  v_mul_f32 v83, v83, v213
  v_mfma_f32_16x16x32_bf16 v[124:127], a[12:15], a[176:179], v[124:127]
  v_cvt_pk_bf16_f32 v224, v80, v81
  s_waitcnt lgkmcnt(1)
  v_mfma_f32_16x16x32_bf16 v[96:99], a[16:19], a[180:183], v[96:99]
  ds_read_b128 a[188:191], v193 offset:28672
  v_cvt_pk_bf16_f32 v225, v82, v83
  v_mfma_f32_16x16x32_bf16 v[100:103], a[20:23], a[180:183], v[100:103]
  v_mul_f32 v88, v88, v92
  v_mfma_f32_16x16x32_bf16 v[104:107], a[24:27], a[180:183], v[104:107]
  v_mul_f32 v89, v89, v93
  v_mul_f32 v90, v90, v94
  v_mfma_f32_16x16x32_bf16 v[108:111], a[28:31], a[180:183], v[108:111]
  v_mul_f32 v91, v91, v95
  s_waitcnt lgkmcnt(1)
  v_mfma_f32_16x16x32_bf16 v[160:163], a[112:115], a[184:187], v[160:163]
  ds_read_b128 a[176:179], v194 offset:20480
  v_mul_f32 v88, v88, v213
  v_mfma_f32_16x16x32_bf16 v[164:167], a[116:119], a[184:187], v[164:167]
  v_mul_f32 v89, v89, v213
  v_mfma_f32_16x16x32_bf16 v[168:171], a[120:123], a[184:187], v[168:171]
  v_mul_f32 v90, v90, v213
  v_mul_f32 v91, v91, v213
  v_mfma_f32_16x16x32_bf16 v[172:175], a[124:127], a[184:187], v[172:175]
  v_cvt_pk_bf16_f32 v226, v88, v89
  s_waitcnt lgkmcnt(1)
  v_mfma_f32_16x16x32_bf16 v[144:147], a[128:131], a[188:191], v[144:147]
  ds_read_b128 a[180:183], v195 offset:12288
  v_cvt_pk_bf16_f32 v227, v90, v91
  v_mfma_f32_16x16x32_bf16 v[148:151], a[132:135], a[188:191], v[148:151]
  buffer_store_dwordx4 v[224:227], v198, s[12:15], s85 offen sc1
  v_mfma_f32_16x16x32_bf16 v[152:155], a[136:139], a[188:191], v[152:155]
  v_mul_f32 v96, v96, v100
  v_mul_f32 v97, v97, v101
  v_mfma_f32_16x16x32_bf16 v[156:159], a[140:143], a[188:191], v[156:159]
  v_mul_f32 v98, v98, v102
  s_waitcnt lgkmcnt(1)
  v_mfma_f32_16x16x32_bf16 v[128:131], a[0:3], a[176:179], v[128:131]
  ds_read_b128 a[184:187], v193 offset:36864
  v_mul_f32 v99, v99, v103
  v_mfma_f32_16x16x32_bf16 v[132:135], a[4:7], a[176:179], v[132:135]
  v_mul_f32 v96, v96, v214
  v_mfma_f32_16x16x32_bf16 v[136:139], a[8:11], a[176:179], v[136:139]
  v_mul_f32 v97, v97, v214
  v_mul_f32 v98, v98, v214
  v_mfma_f32_16x16x32_bf16 v[140:143], a[12:15], a[176:179], v[140:143]
  v_mul_f32 v99, v99, v214
  s_waitcnt lgkmcnt(1)
  v_mfma_f32_16x16x32_bf16 v[112:115], a[16:19], a[180:183], v[112:115]
  ds_read_b128 a[188:191], v194 offset:28672
  v_cvt_pk_bf16_f32 v220, v96, v97
  v_mfma_f32_16x16x32_bf16 v[116:119], a[20:23], a[180:183], v[116:119]
  v_cvt_pk_bf16_f32 v221, v98, v99
  v_mfma_f32_16x16x32_bf16 v[120:123], a[24:27], a[180:183], v[120:123]
  v_mul_f32 v104, v104, v108
  v_mul_f32 v105, v105, v109
  v_mfma_f32_16x16x32_bf16 v[124:127], a[28:31], a[180:183], v[124:127]
  v_mul_f32 v106, v106, v110
  s_waitcnt lgkmcnt(1)
  v_mfma_f32_16x16x32_bf16 v[160:163], a[128:131], a[184:187], v[160:163]
  ds_read_b128 a[176:179], v195 offset:20480
  v_mul_f32 v107, v107, v111
  v_mfma_f32_16x16x32_bf16 v[164:167], a[132:135], a[184:187], v[164:167]
  v_mul_f32 v104, v104, v214
  v_mfma_f32_16x16x32_bf16 v[168:171], a[136:139], a[184:187], v[168:171]
  v_mul_f32 v105, v105, v214
  v_mul_f32 v106, v106, v214
  v_mfma_f32_16x16x32_bf16 v[172:175], a[140:143], a[184:187], v[172:175]
  v_mul_f32 v107, v107, v214
  s_waitcnt lgkmcnt(1)
  v_mfma_f32_16x16x32_bf16 v[144:147], a[0:3], a[188:191], v[144:147]
  ds_read_b128 a[180:183], v194 offset:36864
  v_cvt_pk_bf16_f32 v222, v104, v105
  v_mfma_f32_16x16x32_bf16 v[148:151], a[4:7], a[188:191], v[148:151]
  v_cvt_pk_bf16_f32 v223, v106, v107
  v_mfma_f32_16x16x32_bf16 v[152:155], a[8:11], a[188:191], v[152:155]
  buffer_store_dwordx4 v[220:223], v198, s[12:15], s86 offen sc1
  v_mul_f32 v112, v112, v116
  v_mfma_f32_16x16x32_bf16 v[156:159], a[12:15], a[188:191], v[156:159]
  v_mul_f32 v113, v113, v117
  s_waitcnt lgkmcnt(1)
  v_mfma_f32_16x16x32_bf16 v[128:131], a[16:19], a[176:179], v[128:131]
  ds_read_b128 a[184:187], v195 offset:28672
  v_mul_f32 v114, v114, v118
  v_mfma_f32_16x16x32_bf16 v[132:135], a[20:23], a[176:179], v[132:135]
  v_mul_f32 v115, v115, v119
  v_mfma_f32_16x16x32_bf16 v[136:139], a[24:27], a[176:179], v[136:139]
  v_mul_f32 v112, v112, v215
  v_mul_f32 v113, v113, v215
  v_mfma_f32_16x16x32_bf16 v[140:143], a[28:31], a[176:179], v[140:143]
  v_mul_f32 v114, v114, v215
  s_waitcnt lgkmcnt(1)
  v_mfma_f32_16x16x32_bf16 v[160:163], a[0:3], a[180:183], v[160:163]
  ds_read_b128 a[188:191], v195 offset:36864
  v_mul_f32 v115, v115, v215
  v_mfma_f32_16x16x32_bf16 v[164:167], a[4:7], a[180:183], v[164:167]
  v_cvt_pk_bf16_f32 v224, v112, v113
  v_mfma_f32_16x16x32_bf16 v[168:171], a[8:11], a[180:183], v[168:171]
  v_cvt_pk_bf16_f32 v225, v114, v115
  v_mul_f32 v120, v120, v124
  v_mfma_f32_16x16x32_bf16 v[172:175], a[12:15], a[180:183], v[172:175]
  v_mul_f32 v121, v121, v125
  s_waitcnt lgkmcnt(1)
  v_mfma_f32_16x16x32_bf16 v[144:147], a[16:19], a[184:187], v[144:147]
  v_mul_f32 v122, v122, v126
  v_mfma_f32_16x16x32_bf16 v[148:151], a[20:23], a[184:187], v[148:151]
  v_mul_f32 v123, v123, v127
  v_mfma_f32_16x16x32_bf16 v[152:155], a[24:27], a[184:187], v[152:155]
  v_mul_f32 v120, v120, v215
  v_mul_f32 v121, v121, v215
  v_mfma_f32_16x16x32_bf16 v[156:159], a[28:31], a[184:187], v[156:159]
  s_waitcnt lgkmcnt(0)
  v_mfma_f32_16x16x32_bf16 v[160:163], a[16:19], a[188:191], v[160:163]
  v_mul_f32 v122, v122, v215
  v_mfma_f32_16x16x32_bf16 v[164:167], a[20:23], a[188:191], v[164:167]
  v_mul_f32 v123, v123, v215
  v_mfma_f32_16x16x32_bf16 v[168:171], a[24:27], a[188:191], v[168:171]
  v_cvt_pk_bf16_f32 v226, v120, v121
  v_cvt_pk_bf16_f32 v227, v122, v123
  v_mfma_f32_16x16x32_bf16 v[172:175], a[28:31], a[188:191], v[172:175]
  buffer_store_dwordx4 v[224:227], v198, s[12:15], s87 offen sc1
  v_pk_mul_f32 v[128:129], v[128:129], v[132:133] op_sel:[0,0] op_sel_hi:[1,1]
  v_pk_mul_f32 v[130:131], v[130:131], v[134:135] op_sel:[0,0] op_sel_hi:[1,1]
  v_pk_mul_f32 v[128:129], v[128:129], v[216:217] op_sel:[0,0] op_sel_hi:[1,0]
  v_pk_mul_f32 v[130:131], v[130:131], v[216:217] op_sel:[0,0] op_sel_hi:[1,0]
  v_cvt_pk_bf16_f32 v220, v128, v129
  v_cvt_pk_bf16_f32 v221, v130, v131
  v_pk_mul_f32 v[136:137], v[136:137], v[140:141] op_sel:[0,0] op_sel_hi:[1,1]
  v_pk_mul_f32 v[138:139], v[138:139], v[142:143] op_sel:[0,0] op_sel_hi:[1,1]
  v_pk_mul_f32 v[136:137], v[136:137], v[216:217] op_sel:[0,0] op_sel_hi:[1,0]
  v_pk_mul_f32 v[138:139], v[138:139], v[216:217] op_sel:[0,0] op_sel_hi:[1,0]
  v_cvt_pk_bf16_f32 v222, v136, v137
  v_cvt_pk_bf16_f32 v223, v138, v139
  buffer_store_dwordx4 v[220:223], v198, s[12:15], s88 offen sc1
  v_pk_mul_f32 v[144:145], v[144:145], v[148:149] op_sel:[0,0] op_sel_hi:[1,1]
  v_pk_mul_f32 v[146:147], v[146:147], v[150:151] op_sel:[0,0] op_sel_hi:[1,1]
  v_pk_mul_f32 v[144:145], v[144:145], v[216:217] op_sel:[0,1] op_sel_hi:[1,1]
  v_pk_mul_f32 v[146:147], v[146:147], v[216:217] op_sel:[0,1] op_sel_hi:[1,1]
  v_cvt_pk_bf16_f32 v224, v144, v145
  v_cvt_pk_bf16_f32 v225, v146, v147
  v_pk_mul_f32 v[152:153], v[152:153], v[156:157] op_sel:[0,0] op_sel_hi:[1,1]
  v_pk_mul_f32 v[154:155], v[154:155], v[158:159] op_sel:[0,0] op_sel_hi:[1,1]
  v_pk_mul_f32 v[152:153], v[152:153], v[216:217] op_sel:[0,1] op_sel_hi:[1,1]
  v_pk_mul_f32 v[154:155], v[154:155], v[216:217] op_sel:[0,1] op_sel_hi:[1,1]
  v_cvt_pk_bf16_f32 v226, v152, v153
  v_cvt_pk_bf16_f32 v227, v154, v155
  buffer_store_dwordx4 v[224:227], v198, s[12:15], s89 offen sc1
  v_pk_mul_f32 v[160:161], v[160:161], v[164:165] op_sel:[0,0] op_sel_hi:[1,1]
  v_pk_mul_f32 v[162:163], v[162:163], v[166:167] op_sel:[0,0] op_sel_hi:[1,1]
  v_pk_mul_f32 v[160:161], v[160:161], v[218:219] op_sel:[0,0] op_sel_hi:[1,0]
  v_pk_mul_f32 v[162:163], v[162:163], v[218:219] op_sel:[0,0] op_sel_hi:[1,0]
  v_cvt_pk_bf16_f32 v220, v160, v161
  v_cvt_pk_bf16_f32 v221, v162, v163
  v_pk_mul_f32 v[168:169], v[168:169], v[172:173] op_sel:[0,0] op_sel_hi:[1,1]
  v_pk_mul_f32 v[170:171], v[170:171], v[174:175] op_sel:[0,0] op_sel_hi:[1,1]
  v_pk_mul_f32 v[168:169], v[168:169], v[218:219] op_sel:[0,0] op_sel_hi:[1,0]
  v_pk_mul_f32 v[170:171], v[170:171], v[218:219] op_sel:[0,0] op_sel_hi:[1,0]
  v_cvt_pk_bf16_f32 v222, v168, v169
  v_cvt_pk_bf16_f32 v223, v170, v171
  buffer_store_dwordx4 v[220:223], v198, s[12:15], 0 offen sc1
  s_endpgm
L_k1_kernel_tailP:
  s_add_u32 m0, s27, 81920
  s_add_u32 s28, s56, 0
  s_waitcnt lgkmcnt(1)
  v_mfma_f32_16x16x32_bf16 v[160:163], a[48:51], a[176:179], v[160:163]
  ds_read_b128 a[184:187], v194 offset:24576
  buffer_load_dwordx4 v186, s[4:7], s28 offen  lds
  v_accvgpr_read_b32 v208, a193
  v_mfma_f32_16x16x32_bf16 v[164:167], a[52:55], a[176:179], v[164:167]
  ds_write_b128 v205, v[0:3] offset:0
  ds_write_b128 v205, v[4:7] offset:1024
  v_mul_f32 v208, s33, v208
  v_mfma_f32_16x16x32_bf16 v[168:171], a[56:59], a[176:179], v[168:171]
  ds_write_b128 v205, v[8:11] offset:2048
  ds_write_b128 v205, v[12:15] offset:3072
  v_accvgpr_read_b32 v209, a195
  v_mfma_f32_16x16x32_bf16 v[172:175], a[60:63], a[176:179], v[172:175]
  ds_read_b32 v207, v206 offset:240
  v_mul_f32 v209, s33, v209
  s_waitcnt lgkmcnt(6)
  v_mfma_f32_16x16x32_bf16 v[144:147], a[64:67], a[180:183], v[144:147]
  ds_read_b128 a[188:191], v195 offset:16384
  v_accvgpr_read_b32 v210, a197
  v_mfma_f32_16x16x32_bf16 v[148:151], a[68:71], a[180:183], v[148:151]
  v_mul_f32 v210, s33, v210
  v_mfma_f32_16x16x32_bf16 v[152:155], a[72:75], a[180:183], v[152:155]
  v_accvgpr_read_b32 v211, a199
  v_mul_f32 v211, s33, v211
  v_accvgpr_read_b32 v212, a201
  v_mfma_f32_16x16x32_bf16 v[156:159], a[76:79], a[180:183], v[156:159]
  v_mul_f32 v212, s33, v212
  v_accvgpr_read_b32 v213, a203
  s_waitcnt lgkmcnt(6)
  v_mfma_f32_16x16x32_bf16 v[128:131], a[80:83], a[184:187], v[128:131]
  ds_read_b128 a[176:179], v192 offset:4096
  s_waitcnt lgkmcnt(2)
  v_xor_b32 v204, 0x80000000, v207
  v_mul_f32 v213, s33, v213
  v_mfma_f32_16x16x32_bf16 v[132:135], a[84:87], a[184:187], v[132:135]
  v_mfma_f32_16x16x1_4b_f32 v[0:15], v204, a192, v[0:15]
  s_waitcnt vmcnt(9)
  v_accvgpr_read_b32 v214, a205
  v_mfma_f32_16x16x32_bf16 v[136:139], a[88:91], a[184:187], v[136:139]
  v_mfma_f32_16x16x1_4b_f32 v[16:31], v204, a194, v[16:31]
  v_mul_f32 v214, s33, v214
  s_waitcnt vmcnt(8)
  v_accvgpr_read_b32 v215, a207
  v_mul_f32 v215, s33, v215
  s_waitcnt vmcnt(7)
  v_accvgpr_read_b32 v216, a209
  v_mul_f32 v216, s33, v216
  v_mfma_f32_16x16x32_bf16 v[140:143], a[92:95], a[184:187], v[140:143]
  v_mfma_f32_16x16x1_4b_f32 v[32:47], v204, a196, v[32:47]
  v_mul_f32 v0, v0, v208
  v_mul_f32 v1, v1, v208
  v_mul_f32 v2, v2, v208
  v_mul_f32 v3, v3, v208
  s_waitcnt lgkmcnt(1)
  v_mfma_f32_16x16x32_bf16 v[112:115], a[96:99], a[188:191], v[112:115]
  ds_read_b128 a[180:183], v189 offset:40960
  v_cvt_pk_bf16_f32 v228, v0, v1
  v_mfma_f32_16x16x32_bf16 v[116:119], a[100:103], a[188:191], v[116:119]
  v_cvt_pk_bf16_f32 v229, v2, v3
  v_mfma_f32_16x16x32_bf16 v[120:123], a[104:107], a[188:191], v[120:123]
  v_mul_f32 v8, v8, v208
  v_mul_f32 v9, v9, v208
  v_mul_f32 v10, v10, v208
  v_mfma_f32_16x16x32_bf16 v[124:127], a[108:111], a[188:191], v[124:127]
  v_mul_f32 v11, v11, v208
  v_cvt_pk_bf16_f32 v230, v8, v9
  s_waitcnt lgkmcnt(1)
  v_mfma_f32_16x16x32_bf16 v[96:99], a[112:115], a[176:179], v[96:99]
  ds_read_b128 a[184:187], v190 offset:32768
  v_cvt_pk_bf16_f32 v231, v10, v11
  v_mfma_f32_16x16x32_bf16 v[100:103], a[116:119], a[176:179], v[100:103]
  buffer_store_dwordx4 v[228:231], v199, s[12:15], 0 offen offset:2560 sc1
  v_mfma_f32_16x16x32_bf16 v[104:107], a[120:123], a[176:179], v[104:107]
  v_mul_f32 v4, v4, v208
  v_mul_f32 v5, v5, v208
  v_mul_f32 v6, v6, v208
  v_mfma_f32_16x16x32_bf16 v[108:111], a[124:127], a[176:179], v[108:111]
  v_mul_f32 v7, v7, v208
  v_cvt_pk_bf16_f32 v232, v4, v5
  s_waitcnt lgkmcnt(1)
  v_mfma_f32_16x16x32_bf16 v[80:83], a[128:131], a[180:183], v[80:83]
  ds_read_b128 a[188:191], v191 offset:24576
  v_cvt_pk_bf16_f32 v233, v6, v7
  v_mfma_f32_16x16x32_bf16 v[84:87], a[132:135], a[180:183], v[84:87]
  v_mul_f32 v12, v12, v208
  v_mfma_f32_16x16x32_bf16 v[88:91], a[136:139], a[180:183], v[88:91]
  v_mul_f32 v13, v13, v208
  v_mul_f32 v14, v14, v208
  v_mul_f32 v15, v15, v208
  v_mfma_f32_16x16x32_bf16 v[92:95], a[140:143], a[180:183], v[92:95]
  v_cvt_pk_bf16_f32 v234, v12, v13
  v_cvt_pk_bf16_f32 v235, v14, v15
  s_waitcnt lgkmcnt(1)
  v_mfma_f32_16x16x32_bf16 v[64:67], a[0:3], a[184:187], v[64:67]
  ds_read_b128 a[176:179], v193 offset:40960
  buffer_store_dwordx4 v[232:235], v201, s[12:15], 0 offen offset:2560 sc1
  v_mfma_f32_16x16x32_bf16 v[68:71], a[4:7], a[184:187], v[68:71]
  v_mul_f32 v16, v16, v209
  v_mfma_f32_16x16x32_bf16 v[72:75], a[8:11], a[184:187], v[72:75]
  v_mul_f32 v17, v17, v209
  v_mul_f32 v18, v18, v209
  v_mul_f32 v19, v19, v209
  v_mfma_f32_16x16x32_bf16 v[76:79], a[12:15], a[184:187], v[76:79]
  v_mfma_f32_16x16x1_4b_f32 v[48:63], v204, a198, v[48:63]
  v_cvt_pk_bf16_f32 v236, v16, v17
  v_cvt_pk_bf16_f32 v237, v18, v19
  v_mul_f32 v24, v24, v209
  v_mul_f32 v25, v25, v209
  s_waitcnt lgkmcnt(1)
  v_mfma_f32_16x16x32_bf16 v[48:51], a[16:19], a[188:191], v[48:51]
  ds_read_b128 a[180:183], v194 offset:32768
  v_mul_f32 v26, v26, v209
  v_mfma_f32_16x16x32_bf16 v[52:55], a[20:23], a[188:191], v[52:55]
  v_mul_f32 v27, v27, v209
  v_mfma_f32_16x16x32_bf16 v[56:59], a[24:27], a[188:191], v[56:59]
  v_cvt_pk_bf16_f32 v238, v24, v25
  v_cvt_pk_bf16_f32 v239, v26, v27
  buffer_store_dwordx4 v[236:239], v198, s[12:15], 0 offen offset:2304 sc1
  v_mfma_f32_16x16x32_bf16 v[60:63], a[28:31], a[188:191], v[60:63]
  s_waitcnt vmcnt(4)
  v_mfma_f32_16x16x1_4b_f32 v[160:175], v204, a212, v[160:175]
  v_mul_f32 v20, v20, v209
  v_mul_f32 v21, v21, v209
  v_mul_f32 v22, v22, v209
  s_waitcnt lgkmcnt(1)
  v_mfma_f32_16x16x32_bf16 v[160:163], a[64:67], a[176:179], v[160:163]
  ds_read_b128 a[184:187], v195 offset:24576
  v_mfma_f32_16x16x32_bf16 v[164:167], a[68:71], a[176:179], v[164:167]
  v_mul_f32 v23, v23, v209
  v_mfma_f32_16x16x32_bf16 v[168:171], a[72:75], a[176:179], v[168:171]
  v_cvt_pk_bf16_f32 v228, v20, v21
  v_cvt_pk_bf16_f32 v229, v22, v23
  v_mul_f32 v28, v28, v209
  v_mfma_f32_16x16x32_bf16 v[172:175], a[76:79], a[176:179], v[172:175]
  v_mfma_f32_16x16x1_4b_f32 v[144:159], v204, a210, v[144:159]
  v_mul_f32 v29, v29, v209
  v_mul_f32 v30, v30, v209
  v_mul_f32 v31, v31, v209
  v_cvt_pk_bf16_f32 v230, v28, v29
  s_waitcnt lgkmcnt(1)
  v_mfma_f32_16x16x32_bf16 v[144:147], a[80:83], a[180:183], v[144:147]
  ds_read_b128 a[188:191], v192 offset:12288
  v_cvt_pk_bf16_f32 v231, v30, v31
  v_mfma_f32_16x16x32_bf16 v[148:151], a[84:87], a[180:183], v[148:151]
  buffer_store_dwordx4 v[228:231], v200, s[12:15], 0 offen offset:2304 sc1
  v_mfma_f32_16x16x32_bf16 v[152:155], a[88:91], a[180:183], v[152:155]
  v_mul_f32 v32, v32, v210
  v_mul_f32 v33, v33, v210
  v_mul_f32 v34, v34, v210
  v_mfma_f32_16x16x32_bf16 v[156:159], a[92:95], a[180:183], v[156:159]
  v_mfma_f32_16x16x1_4b_f32 v[128:143], v204, a208, v[128:143]
  v_mul_f32 v35, v35, v210
  v_cvt_pk_bf16_f32 v232, v32, v33
  v_cvt_pk_bf16_f32 v233, v34, v35
  v_mul_f32 v40, v40, v210
  s_waitcnt lgkmcnt(1)
  v_mfma_f32_16x16x32_bf16 v[128:131], a[96:99], a[184:187], v[128:131]
  ds_read_b128 a[176:179], v193 offset:4096
  v_mul_f32 v41, v41, v210
  v_mfma_f32_16x16x32_bf16 v[132:135], a[100:103], a[184:187], v[132:135]
  v_mul_f32 v42, v42, v210
  v_mfma_f32_16x16x32_bf16 v[136:139], a[104:107], a[184:187], v[136:139]
  v_mul_f32 v43, v43, v210
  v_cvt_pk_bf16_f32 v234, v40, v41
  v_cvt_pk_bf16_f32 v235, v42, v43
  v_mfma_f32_16x16x32_bf16 v[140:143], a[108:111], a[184:187], v[140:143]
  v_mfma_f32_16x16x1_4b_f32 v[112:127], v204, a206, v[112:127]
  buffer_store_dwordx4 v[232:235], v198, s[12:15], 0 offen offset:2048 sc1
  v_mul_f32 v36, v36, v210
  v_mul_f32 v37, v37, v210
  v_mul_f32 v38, v38, v210
  s_waitcnt lgkmcnt(1)
  v_mfma_f32_16x16x32_bf16 v[112:115], a[112:115], a[188:191], v[112:115]
  ds_read_b128 a[180:183], v190 offset:40960
  v_mul_f32 v39, v39, v210
  v_mfma_f32_16x16x32_bf16 v[116:119], a[116:119], a[188:191], v[116:119]
  v_cvt_pk_bf16_f32 v236, v36, v37
  v_mfma_f32_16x16x32_bf16 v[120:123], a[120:123], a[188:191], v[120:123]
  v_cvt_pk_bf16_f32 v237, v38, v39
  v_mul_f32 v44, v44, v210
  v_mul_f32 v45, v45, v210
  v_mfma_f32_16x16x32_bf16 v[124:127], a[124:127], a[188:191], v[124:127]
  v_mfma_f32_16x16x1_4b_f32 v[96:111], v204, a204, v[96:111]
  v_mul_f32 v46, v46, v210
  v_mul_f32 v47, v47, v210
  v_cvt_pk_bf16_f32 v238, v44, v45
  v_cvt_pk_bf16_f32 v239, v46, v47
  s_waitcnt lgkmcnt(1)
  v_mfma_f32_16x16x32_bf16 v[96:99], a[128:131], a[176:179], v[96:99]
  ds_read_b128 a[184:187], v191 offset:32768
  buffer_store_dwordx4 v[236:239], v200, s[12:15], 0 offen offset:2048 sc1
  v_mfma_f32_16x16x32_bf16 v[100:103], a[132:135], a[176:179], v[100:103]
  v_mul_f32 v48, v48, v211
  v_mfma_f32_16x16x32_bf16 v[104:107], a[136:139], a[176:179], v[104:107]
  v_mul_f32 v49, v49, v211
  v_mul_f32 v50, v50, v211
  v_mul_f32 v51, v51, v211
  v_mfma_f32_16x16x32_bf16 v[108:111], a[140:143], a[176:179], v[108:111]
  v_mfma_f32_16x16x1_4b_f32 v[80:95], v204, a202, v[80:95]
  v_cvt_pk_bf16_f32 v228, v48, v49
  v_cvt_pk_bf16_f32 v229, v50, v51
  v_mul_f32 v56, v56, v211
  v_mul_f32 v57, v57, v211
  s_waitcnt lgkmcnt(1)
  v_mfma_f32_16x16x32_bf16 v[80:83], a[0:3], a[180:183], v[80:83]
  ds_read_b128 a[188:191], v194 offset:40960
  v_mul_f32 v58, v58, v211
  v_mfma_f32_16x16x32_bf16 v[84:87], a[4:7], a[180:183], v[84:87]
  v_mul_f32 v59, v59, v211
  v_mfma_f32_16x16x32_bf16 v[88:91], a[8:11], a[180:183], v[88:91]
  v_cvt_pk_bf16_f32 v230, v56, v57
  v_cvt_pk_bf16_f32 v231, v58, v59
  buffer_store_dwordx4 v[228:231], v198, s[12:15], 0 offen offset:1792 sc1
  v_mfma_f32_16x16x32_bf16 v[92:95], a[12:15], a[180:183], v[92:95]
  v_mfma_f32_16x16x1_4b_f32 v[64:79], v204, a200, v[64:79]
  v_mul_f32 v52, v52, v211
  v_mul_f32 v53, v53, v211
  v_mul_f32 v54, v54, v211
  v_mul_f32 v55, v55, v211
  s_waitcnt lgkmcnt(1)
  v_mfma_f32_16x16x32_bf16 v[64:67], a[16:19], a[184:187], v[64:67]
  ds_read_b128 a[176:179], v195 offset:32768
  v_cvt_pk_bf16_f32 v232, v52, v53
  v_mfma_f32_16x16x32_bf16 v[68:71], a[20:23], a[184:187], v[68:71]
  v_cvt_pk_bf16_f32 v233, v54, v55
  v_mfma_f32_16x16x32_bf16 v[72:75], a[24:27], a[184:187], v[72:75]
  v_mul_f32 v60, v60, v211
  v_mul_f32 v61, v61, v211
  v_mul_f32 v62, v62, v211
  v_mfma_f32_16x16x32_bf16 v[76:79], a[28:31], a[184:187], v[76:79]
  s_waitcnt vmcnt(7)
  s_barrier
  v_accvgpr_read_b32 v218, a213
  v_mul_f32 v218, s33, v218
  s_waitcnt lgkmcnt(1)
  v_mfma_f32_16x16x32_bf16 v[160:163], a[80:83], a[188:191], v[160:163]
  ds_read_b128 a[180:183], v192 offset:20480
  v_mfma_f32_16x16x32_bf16 v[164:167], a[84:87], a[188:191], v[164:167]
  v_accvgpr_read_b32 v217, a211
  v_mfma_f32_16x16x32_bf16 v[168:171], a[88:91], a[188:191], v[168:171]
  v_mul_f32 v217, s33, v217
  v_mul_f32 v63, v63, v211
  v_cvt_pk_bf16_f32 v234, v60, v61
  v_mfma_f32_16x16x32_bf16 v[172:175], a[92:95], a[188:191], v[172:175]
  v_cvt_pk_bf16_f32 v235, v62, v63
  buffer_store_dwordx4 v[232:235], v200, s[12:15], 0 offen offset:1792 sc1
  s_waitcnt lgkmcnt(1)
  v_mfma_f32_16x16x32_bf16 v[144:147], a[96:99], a[176:179], v[144:147]
  ds_read_b128 a[184:187], v193 offset:12288
  v_mfma_f32_16x16x32_bf16 v[148:151], a[100:103], a[176:179], v[148:151]
  v_mul_f32 v64, v64, v212
  v_mfma_f32_16x16x32_bf16 v[152:155], a[104:107], a[176:179], v[152:155]
  v_mul_f32 v65, v65, v212
  v_mul_f32 v66, v66, v212
  v_mul_f32 v67, v67, v212
  v_mfma_f32_16x16x32_bf16 v[156:159], a[108:111], a[176:179], v[156:159]
  v_cvt_pk_bf16_f32 v236, v64, v65
  s_waitcnt lgkmcnt(1)
  v_mfma_f32_16x16x32_bf16 v[128:131], a[112:115], a[180:183], v[128:131]
  ds_read_b128 a[188:191], v194 offset:4096
  v_mfma_f32_16x16x32_bf16 v[132:135], a[116:119], a[180:183], v[132:135]
  v_cvt_pk_bf16_f32 v237, v66, v67
  v_mfma_f32_16x16x32_bf16 v[136:139], a[120:123], a[180:183], v[136:139]
  v_mul_f32 v72, v72, v212
  v_mul_f32 v73, v73, v212
  v_mul_f32 v74, v74, v212
  v_mfma_f32_16x16x32_bf16 v[140:143], a[124:127], a[180:183], v[140:143]
  v_mul_f32 v75, v75, v212
  v_cvt_pk_bf16_f32 v238, v72, v73
  s_waitcnt lgkmcnt(1)
  v_mfma_f32_16x16x32_bf16 v[112:115], a[128:131], a[184:187], v[112:115]
  ds_read_b128 a[176:179], v191 offset:40960
  v_mfma_f32_16x16x32_bf16 v[116:119], a[132:135], a[184:187], v[116:119]
  v_cvt_pk_bf16_f32 v239, v74, v75
  v_mfma_f32_16x16x32_bf16 v[120:123], a[136:139], a[184:187], v[120:123]
  buffer_store_dwordx4 v[236:239], v198, s[12:15], 0 offen offset:1536 sc1
  v_mul_f32 v68, v68, v212
  v_mul_f32 v69, v69, v212
  v_mfma_f32_16x16x32_bf16 v[124:127], a[140:143], a[184:187], v[124:127]
  v_mul_f32 v70, v70, v212
  v_mul_f32 v71, v71, v212
  s_waitcnt lgkmcnt(1)
  v_mfma_f32_16x16x32_bf16 v[96:99], a[0:3], a[188:191], v[96:99]
  ds_read_b128 a[180:183], v195 offset:40960
  v_mfma_f32_16x16x32_bf16 v[100:103], a[4:7], a[188:191], v[100:103]
  v_cvt_pk_bf16_f32 v228, v68, v69
  v_mfma_f32_16x16x32_bf16 v[104:107], a[8:11], a[188:191], v[104:107]
  v_cvt_pk_bf16_f32 v229, v70, v71
  v_mul_f32 v76, v76, v212
  v_mul_f32 v77, v77, v212
  v_mfma_f32_16x16x32_bf16 v[108:111], a[12:15], a[188:191], v[108:111]
  v_mul_f32 v78, v78, v212
  s_waitcnt lgkmcnt(1)
  v_mfma_f32_16x16x32_bf16 v[80:83], a[16:19], a[176:179], v[80:83]
  ds_read_b128 a[184:187], v192 offset:28672
  v_mfma_f32_16x16x32_bf16 v[84:87], a[20:23], a[176:179], v[84:87]
  v_mul_f32 v79, v79, v212
  v_mfma_f32_16x16x32_bf16 v[88:91], a[24:27], a[176:179], v[88:91]
  v_cvt_pk_bf16_f32 v230, v76, v77
  v_cvt_pk_bf16_f32 v231, v78, v79
  buffer_store_dwordx4 v[228:231], v200, s[12:15], 0 offen offset:1536 sc1
  v_mfma_f32_16x16x32_bf16 v[92:95], a[28:31], a[176:179], v[92:95]
  s_waitcnt lgkmcnt(1)
  v_mfma_f32_16x16x32_bf16 v[160:163], a[96:99], a[180:183], v[160:163]
  ds_read_b128 a[188:191], v193 offset:20480
  v_mfma_f32_16x16x32_bf16 v[164:167], a[100:103], a[180:183], v[164:167]
  v_mul_f32 v80, v80, v213
  v_mfma_f32_16x16x32_bf16 v[168:171], a[104:107], a[180:183], v[168:171]
  v_mul_f32 v81, v81, v213
  v_mul_f32 v82, v82, v213
  v_mul_f32 v83, v83, v213
  v_mfma_f32_16x16x32_bf16 v[172:175], a[108:111], a[180:183], v[172:175]
  v_cvt_pk_bf16_f32 v232, v80, v81
  v_cvt_pk_bf16_f32 v233, v82, v83
  s_waitcnt lgkmcnt(1)
  v_mfma_f32_16x16x32_bf16 v[144:147], a[112:115], a[184:187], v[144:147]
  ds_read_b128 a[176:179], v194 offset:12288
  v_mul_f32 v88, v88, v213
  v_mfma_f32_16x16x32_bf16 v[148:151], a[116:119], a[184:187], v[148:151]
  v_mul_f32 v89, v89, v213
  v_mfma_f32_16x16x32_bf16 v[152:155], a[120:123], a[184:187], v[152:155]
  v_mul_f32 v90, v90, v213
  v_mul_f32 v91, v91, v213
  v_cvt_pk_bf16_f32 v234, v88, v89
  v_mfma_f32_16x16x32_bf16 v[156:159], a[124:127], a[184:187], v[156:159]
  v_cvt_pk_bf16_f32 v235, v90, v91
  s_waitcnt lgkmcnt(1)
  v_mfma_f32_16x16x32_bf16 v[128:131], a[128:131], a[188:191], v[128:131]
  ds_read_b128 a[180:183], v195 offset:4096
  v_mfma_f32_16x16x32_bf16 v[132:135], a[132:135], a[188:191], v[132:135]
  buffer_store_dwordx4 v[232:235], v198, s[12:15], 0 offen offset:1280 sc1
  v_mfma_f32_16x16x32_bf16 v[136:139], a[136:139], a[188:191], v[136:139]
  v_mul_f32 v84, v84, v213
  v_mul_f32 v85, v85, v213
  v_mul_f32 v86, v86, v213
  v_mfma_f32_16x16x32_bf16 v[140:143], a[140:143], a[188:191], v[140:143]
  v_mul_f32 v87, v87, v213
  s_waitcnt lgkmcnt(1)
  v_mfma_f32_16x16x32_bf16 v[112:115], a[0:3], a[176:179], v[112:115]
  ds_read_b128 a[184:187], v192 offset:36864
  v_mfma_f32_16x16x32_bf16 v[116:119], a[4:7], a[176:179], v[116:119]
  v_cvt_pk_bf16_f32 v236, v84, v85
  v_mfma_f32_16x16x32_bf16 v[120:123], a[8:11], a[176:179], v[120:123]
  v_cvt_pk_bf16_f32 v237, v86, v87
  v_mul_f32 v92, v92, v213
  v_mul_f32 v93, v93, v213
  v_mfma_f32_16x16x32_bf16 v[124:127], a[12:15], a[176:179], v[124:127]
  v_mul_f32 v94, v94, v213
  v_mul_f32 v95, v95, v213
  s_waitcnt lgkmcnt(1)
  v_mfma_f32_16x16x32_bf16 v[96:99], a[16:19], a[180:183], v[96:99]
  ds_read_b128 a[188:191], v193 offset:28672
  v_mfma_f32_16x16x32_bf16 v[100:103], a[20:23], a[180:183], v[100:103]
  v_cvt_pk_bf16_f32 v238, v92, v93
  v_mfma_f32_16x16x32_bf16 v[104:107], a[24:27], a[180:183], v[104:107]
  v_cvt_pk_bf16_f32 v239, v94, v95
  buffer_store_dwordx4 v[236:239], v200, s[12:15], 0 offen offset:1280 sc1
  v_mfma_f32_16x16x32_bf16 v[108:111], a[28:31], a[180:183], v[108:111]
  s_waitcnt lgkmcnt(1)
  v_mfma_f32_16x16x32_bf16 v[160:163], a[112:115], a[184:187], v[160:163]
  ds_read_b128 a[176:179], v194 offset:20480
  v_mfma_f32_16x16x32_bf16 v[164:167], a[116:119], a[184:187], v[164:167]
  v_mul_f32 v96, v96, v214
  v_mfma_f32_16x16x32_bf16 v[168:171], a[120:123], a[184:187], v[168:171]
  v_mul_f32 v97, v97, v214
  v_mul_f32 v98, v98, v214
  v_mul_f32 v99, v99, v214
  v_mfma_f32_16x16x32_bf16 v[172:175], a[124:127], a[184:187], v[172:175]
  v_cvt_pk_bf16_f32 v228, v96, v97
  v_cvt_pk_bf16_f32 v229, v98, v99
  s_waitcnt lgkmcnt(1)
  v_mfma_f32_16x16x32_bf16 v[144:147], a[128:131], a[188:191], v[144:147]
  ds_read_b128 a[180:183], v195 offset:12288
  v_mul_f32 v104, v104, v214
  v_mfma_f32_16x16x32_bf16 v[148:151], a[132:135], a[188:191], v[148:151]
  v_mul_f32 v105, v105, v214
  v_mfma_f32_16x16x32_bf16 v[152:155], a[136:139], a[188:191], v[152:155]
  v_mul_f32 v106, v106, v214
  v_mul_f32 v107, v107, v214
  v_cvt_pk_bf16_f32 v230, v104, v105
  v_mfma_f32_16x16x32_bf16 v[156:159], a[140:143], a[188:191], v[156:159]
  v_cvt_pk_bf16_f32 v231, v106, v107
  buffer_store_dwordx4 v[228:231], v198, s[12:15], 0 offen offset:1024 sc1
  s_waitcnt lgkmcnt(1)
  v_mfma_f32_16x16x32_bf16 v[128:131], a[0:3], a[176:179], v[128:131]
  ds_read_b128 a[184:187], v193 offset:36864
  v_mul_f32 v100, v100, v214
  v_mfma_f32_16x16x32_bf16 v[132:135], a[4:7], a[176:179], v[132:135]
  v_mul_f32 v101, v101, v214
  v_mfma_f32_16x16x32_bf16 v[136:139], a[8:11], a[176:179], v[136:139]
  v_mul_f32 v102, v102, v214
  v_mul_f32 v103, v103, v214
  v_cvt_pk_bf16_f32 v232, v100, v101
  v_mfma_f32_16x16x32_bf16 v[140:143], a[12:15], a[176:179], v[140:143]
  v_cvt_pk_bf16_f32 v233, v102, v103
  v_mul_f32 v108, v108, v214
  s_waitcnt lgkmcnt(1)
  v_mfma_f32_16x16x32_bf16 v[112:115], a[16:19], a[180:183], v[112:115]
  ds_read_b128 a[188:191], v194 offset:28672
  v_mul_f32 v109, v109, v214
  v_mfma_f32_16x16x32_bf16 v[116:119], a[20:23], a[180:183], v[116:119]
  v_mul_f32 v110, v110, v214
  v_mfma_f32_16x16x32_bf16 v[120:123], a[24:27], a[180:183], v[120:123]
  v_mul_f32 v111, v111, v214
  v_cvt_pk_bf16_f32 v234, v108, v109
  v_cvt_pk_bf16_f32 v235, v110, v111
  v_mfma_f32_16x16x32_bf16 v[124:127], a[28:31], a[180:183], v[124:127]
  buffer_store_dwordx4 v[232:235], v200, s[12:15], 0 offen offset:1024 sc1
  s_waitcnt lgkmcnt(1)
  v_mfma_f32_16x16x32_bf16 v[160:163], a[128:131], a[184:187], v[160:163]
  ds_read_b128 a[176:179], v195 offset:20480
  v_mfma_f32_16x16x32_bf16 v[164:167], a[132:135], a[184:187], v[164:167]
  v_mul_f32 v112, v112, v215
  v_mfma_f32_16x16x32_bf16 v[168:171], a[136:139], a[184:187], v[168:171]
  v_mul_f32 v113, v113, v215
  v_mul_f32 v114, v114, v215
  v_mul_f32 v115, v115, v215
  v_mfma_f32_16x16x32_bf16 v[172:175], a[140:143], a[184:187], v[172:175]
  v_cvt_pk_bf16_f32 v236, v112, v113
  v_cvt_pk_bf16_f32 v237, v114, v115
  s_waitcnt lgkmcnt(1)
  v_mfma_f32_16x16x32_bf16 v[144:147], a[0:3], a[188:191], v[144:147]
  ds_read_b128 a[180:183], v194 offset:36864
  v_mul_f32 v120, v120, v215
  v_mfma_f32_16x16x32_bf16 v[148:151], a[4:7], a[188:191], v[148:151]
  v_mul_f32 v121, v121, v215
  v_mfma_f32_16x16x32_bf16 v[152:155], a[8:11], a[188:191], v[152:155]
  v_mul_f32 v122, v122, v215
  v_mul_f32 v123, v123, v215
  v_cvt_pk_bf16_f32 v238, v120, v121
  v_mfma_f32_16x16x32_bf16 v[156:159], a[12:15], a[188:191], v[156:159]
  v_cvt_pk_bf16_f32 v239, v122, v123
  buffer_store_dwordx4 v[236:239], v198, s[12:15], 0 offen offset:768 sc1
  s_waitcnt lgkmcnt(1)
  v_mfma_f32_16x16x32_bf16 v[128:131], a[16:19], a[176:179], v[128:131]
  ds_read_b128 a[184:187], v195 offset:28672
  v_mul_f32 v116, v116, v215
  v_mfma_f32_16x16x32_bf16 v[132:135], a[20:23], a[176:179], v[132:135]
  v_mul_f32 v117, v117, v215
  v_mfma_f32_16x16x32_bf16 v[136:139], a[24:27], a[176:179], v[136:139]
  v_mul_f32 v118, v118, v215
  v_mul_f32 v119, v119, v215
  v_cvt_pk_bf16_f32 v228, v116, v117
  v_mfma_f32_16x16x32_bf16 v[140:143], a[28:31], a[176:179], v[140:143]
  v_cvt_pk_bf16_f32 v229, v118, v119
  v_mul_f32 v124, v124, v215
  s_waitcnt lgkmcnt(1)
  v_mfma_f32_16x16x32_bf16 v[160:163], a[0:3], a[180:183], v[160:163]
  ds_read_b128 a[188:191], v195 offset:36864
  v_mul_f32 v125, v125, v215
  v_mfma_f32_16x16x32_bf16 v[164:167], a[4:7], a[180:183], v[164:167]
  v_mul_f32 v126, v126, v215
  v_mfma_f32_16x16x32_bf16 v[168:171], a[8:11], a[180:183], v[168:171]
  v_mul_f32 v127, v127, v215
  v_cvt_pk_bf16_f32 v230, v124, v125
  v_cvt_pk_bf16_f32 v231, v126, v127
  v_mfma_f32_16x16x32_bf16 v[172:175], a[12:15], a[180:183], v[172:175]
  buffer_store_dwordx4 v[228:231], v200, s[12:15], 0 offen offset:768 sc1
  s_waitcnt lgkmcnt(1)
  v_mfma_f32_16x16x32_bf16 v[144:147], a[16:19], a[184:187], v[144:147]
  v_mul_f32 v128, v128, v216
  v_mfma_f32_16x16x32_bf16 v[148:151], a[20:23], a[184:187], v[148:151]
  v_mul_f32 v129, v129, v216
  v_mfma_f32_16x16x32_bf16 v[152:155], a[24:27], a[184:187], v[152:155]
  v_mul_f32 v130, v130, v216
  v_mul_f32 v131, v131, v216
  v_cvt_pk_bf16_f32 v232, v128, v129
  v_mfma_f32_16x16x32_bf16 v[156:159], a[28:31], a[184:187], v[156:159]
  s_waitcnt lgkmcnt(0)
  v_mfma_f32_16x16x32_bf16 v[160:163], a[16:19], a[188:191], v[160:163]
  v_cvt_pk_bf16_f32 v233, v130, v131
  v_mfma_f32_16x16x32_bf16 v[164:167], a[20:23], a[188:191], v[164:167]
  v_mul_f32 v136, v136, v216
  v_mfma_f32_16x16x32_bf16 v[168:171], a[24:27], a[188:191], v[168:171]
  v_mul_f32 v137, v137, v216
  v_mul_f32 v138, v138, v216
  v_mul_f32 v139, v139, v216
  v_mfma_f32_16x16x32_bf16 v[172:175], a[28:31], a[188:191], v[172:175]
  v_cvt_pk_bf16_f32 v234, v136, v137
  v_cvt_pk_bf16_f32 v235, v138, v139
  buffer_store_dwordx4 v[232:235], v198, s[12:15], 0 offen offset:512 sc1
  v_mul_f32 v132, v132, v216
  v_mul_f32 v133, v133, v216
  v_mul_f32 v134, v134, v216
  v_mul_f32 v135, v135, v216
  v_cvt_pk_bf16_f32 v236, v132, v133
  v_cvt_pk_bf16_f32 v237, v134, v135
  v_mul_f32 v140, v140, v216
  v_mul_f32 v141, v141, v216
  v_mul_f32 v142, v142, v216
  v_mul_f32 v143, v143, v216
  v_cvt_pk_bf16_f32 v238, v140, v141
  v_cvt_pk_bf16_f32 v239, v142, v143
  buffer_store_dwordx4 v[236:239], v200, s[12:15], 0 offen offset:512 sc1
  v_pk_mul_f32 v[144:145], v[144:145], v[216:217] op_sel:[0,1] op_sel_hi:[1,1]
  v_pk_mul_f32 v[146:147], v[146:147], v[216:217] op_sel:[0,1] op_sel_hi:[1,1]
  v_cvt_pk_bf16_f32 v228, v144, v145
  v_cvt_pk_bf16_f32 v229, v146, v147
  v_pk_mul_f32 v[152:153], v[152:153], v[216:217] op_sel:[0,1] op_sel_hi:[1,1]
  v_pk_mul_f32 v[154:155], v[154:155], v[216:217] op_sel:[0,1] op_sel_hi:[1,1]
  v_cvt_pk_bf16_f32 v230, v152, v153
  v_cvt_pk_bf16_f32 v231, v154, v155
  buffer_store_dwordx4 v[228:231], v198, s[12:15], 0 offen offset:256 sc1
  v_pk_mul_f32 v[148:149], v[148:149], v[216:217] op_sel:[0,1] op_sel_hi:[1,1]
  v_pk_mul_f32 v[150:151], v[150:151], v[216:217] op_sel:[0,1] op_sel_hi:[1,1]
  v_cvt_pk_bf16_f32 v232, v148, v149
  v_cvt_pk_bf16_f32 v233, v150, v151
  v_pk_mul_f32 v[156:157], v[156:157], v[216:217] op_sel:[0,1] op_sel_hi:[1,1]
  v_pk_mul_f32 v[158:159], v[158:159], v[216:217] op_sel:[0,1] op_sel_hi:[1,1]
  v_cvt_pk_bf16_f32 v234, v156, v157
  v_cvt_pk_bf16_f32 v235, v158, v159
  buffer_store_dwordx4 v[232:235], v200, s[12:15], 0 offen offset:256 sc1
  v_pk_mul_f32 v[160:161], v[160:161], v[218:219] op_sel:[0,0] op_sel_hi:[1,0]
  v_pk_mul_f32 v[162:163], v[162:163], v[218:219] op_sel:[0,0] op_sel_hi:[1,0]
  v_cvt_pk_bf16_f32 v236, v160, v161
  v_cvt_pk_bf16_f32 v237, v162, v163
  v_pk_mul_f32 v[168:169], v[168:169], v[218:219] op_sel:[0,0] op_sel_hi:[1,0]
  v_pk_mul_f32 v[170:171], v[170:171], v[218:219] op_sel:[0,0] op_sel_hi:[1,0]
  v_cvt_pk_bf16_f32 v238, v168, v169
  v_cvt_pk_bf16_f32 v239, v170, v171
  buffer_store_dwordx4 v[236:239], v198, s[12:15], 0 offen offset:0 sc1
  v_pk_mul_f32 v[164:165], v[164:165], v[218:219] op_sel:[0,0] op_sel_hi:[1,0]
  v_pk_mul_f32 v[166:167], v[166:167], v[218:219] op_sel:[0,0] op_sel_hi:[1,0]
  v_cvt_pk_bf16_f32 v228, v164, v165
  v_cvt_pk_bf16_f32 v229, v166, v167
  v_pk_mul_f32 v[172:173], v[172:173], v[218:219] op_sel:[0,0] op_sel_hi:[1,0]
  v_pk_mul_f32 v[174:175], v[174:175], v[218:219] op_sel:[0,0] op_sel_hi:[1,0]
  v_cvt_pk_bf16_f32 v230, v172, v173
  v_cvt_pk_bf16_f32 v231, v174, v175
  buffer_store_dwordx4 v[228:231], v200, s[12:15], 0 offen offset:0 sc1
  s_endpgm
L_k1_kernel_spare:
  s_and_b32 s22, s32, 3
  s_lshl_b32 s22, s22, 10
  s_add_u32 s22, s22, 24117248
  v_lshlrev_b32 v1, 2, v0
  v_mov_b32 v2, 0
  buffer_store_dword v2, v1, s[12:15], s22 offen sc1
  s_waitcnt vmcnt(5)
  v_lshlrev_b32 v144, 16, v222
  v_and_b32 v145, 0xffff0000, v222
  v_lshlrev_b32 v146, 16, v223
  v_and_b32 v147, 0xffff0000, v223
  s_waitcnt vmcnt(4)
  v_lshlrev_b32 v148, 16, v224
  v_and_b32 v149, 0xffff0000, v224
  v_lshlrev_b32 v150, 16, v225
  v_and_b32 v151, 0xffff0000, v225
  s_waitcnt vmcnt(3)
  v_lshlrev_b32 v152, 16, v226
  v_and_b32 v153, 0xffff0000, v226
  v_lshlrev_b32 v154, 16, v227
  v_and_b32 v155, 0xffff0000, v227
  s_waitcnt vmcnt(2)
  v_lshlrev_b32 v156, 16, v228
  v_and_b32 v157, 0xffff0000, v228
  v_lshlrev_b32 v158, 16, v229
  v_and_b32 v159, 0xffff0000, v229
  s_waitcnt vmcnt(1)
  v_lshlrev_b32 v160, 16, v230
  v_and_b32 v161, 0xffff0000, v230
  v_lshlrev_b32 v162, 16, v231
  v_and_b32 v163, 0xffff0000, v231
  v_mov_b32 v164, v144
  v_mov_b32 v165, v145
  v_mov_b32 v166, v146
  v_mov_b32 v167, v147
  v_add_f32 v164, v164, v148
  v_add_f32 v165, v165, v149
  v_add_f32 v166, v166, v150
  v_add_f32 v167, v167, v151
  v_add_f32 v164, v164, v152
  v_add_f32 v165, v165, v153
  v_add_f32 v166, v166, v154
  v_add_f32 v167, v167, v155
  v_add_f32 v164, v164, v156
  v_add_f32 v165, v165, v157
  v_add_f32 v166, v166, v158
  v_add_f32 v167, v167, v159
  v_add_f32 v164, v164, v160
  v_add_f32 v165, v165, v161
  v_add_f32 v166, v166, v162
  v_add_f32 v167, v167, v163
  v_add_f32 v164, v164, v165
  v_add_f32 v166, v166, v167
  v_add_f32 v232, v164, v166
  s_nop 1
  v_add_f32_dpp v232, v232, v232 row_ror:8 row_mask:0xf bank_mask:0xf
  s_nop 1
  v_add_f32_dpp v232, v232, v232 row_ror:4 row_mask:0xf bank_mask:0xf
  s_nop 1
  v_add_f32_dpp v232, v232, v232 row_ror:2 row_mask:0xf bank_mask:0xf
  s_nop 1
  v_add_f32_dpp v232, v232, v232 row_ror:1 row_mask:0xf bank_mask:0xf
  v_mov_b32 v233, v232
  s_nop 1
  v_permlane16_swap_b32 v232, v233
  v_add_f32 v232, v232, v233
  v_mul_f32 v232, 0x3acccccd, v232
  v_sub_f32 v144, v144, v232
  v_sub_f32 v145, v145, v232
  v_sub_f32 v146, v146, v232
  v_sub_f32 v147, v147, v232
  v_sub_f32 v148, v148, v232
  v_sub_f32 v149, v149, v232
  v_sub_f32 v150, v150, v232
  v_sub_f32 v151, v151, v232
  v_sub_f32 v152, v152, v232
  v_sub_f32 v153, v153, v232
  v_sub_f32 v154, v154, v232
  v_sub_f32 v155, v155, v232
  v_sub_f32 v156, v156, v232
  v_sub_f32 v157, v157, v232
  v_sub_f32 v158, v158, v232
  v_sub_f32 v159, v159, v232
  v_sub_f32 v160, v160, v232
  v_sub_f32 v161, v161, v232
  v_sub_f32 v162, v162, v232
  v_sub_f32 v163, v163, v232
  v_mul_f32 v164, v144, v144
  v_mul_f32 v165, v145, v145
  v_mul_f32 v166, v146, v146
  v_mul_f32 v167, v147, v147
  v_fmac_f32 v164, v148, v148
  v_fmac_f32 v165, v149, v149
  v_fmac_f32 v166, v150, v150
  v_fmac_f32 v167, v151, v151
  v_fmac_f32 v164, v152, v152
  v_fmac_f32 v165, v153, v153
  v_fmac_f32 v166, v154, v154
  v_fmac_f32 v167, v155, v155
  v_fmac_f32 v164, v156, v156
  v_fmac_f32 v165, v157, v157
  v_fmac_f32 v166, v158, v158
  v_fmac_f32 v167, v159, v159
  v_fmac_f32 v164, v160, v160
  v_fmac_f32 v165, v161, v161
  v_fmac_f32 v166, v162, v162
  v_fmac_f32 v167, v163, v163
  v_add_f32 v164, v164, v165
  v_add_f32 v166, v166, v167
  v_add_f32 v234, v164, v166
  s_nop 1
  v_add_f32_dpp v234, v234, v234 row_ror:8 row_mask:0xf bank_mask:0xf
  s_nop 1
  v_add_f32_dpp v234, v234, v234 row_ror:4 row_mask:0xf bank_mask:0xf
  s_nop 1
  v_add_f32_dpp v234, v234, v234 row_ror:2 row_mask:0xf bank_mask:0xf
  s_nop 1
  v_add_f32_dpp v234, v234, v234 row_ror:1 row_mask:0xf bank_mask:0xf
  v_mov_b32 v233, v234
  s_nop 1
  v_permlane16_swap_b32 v234, v233
  v_add_f32 v234, v234, v233
  v_mul_f32 v234, 0x3acccccd, v234
  v_cvt_pk_bf16_f32 v235, v232, v234
  v_lshlrev_b32 v236, 16, v235
  v_and_b32 v234, 0xffff0000, v235
  v_add_f32 v234, 0x3727c5ac, v234
  v_cvt_pk_bf16_f32 v234, v234, v234
  v_and_b32 v234, 0xffff0000, v234
  v_sqrt_f32 v234, v234
  s_nop 0
  v_cvt_pk_bf16_f32 v234, v234, v234
  v_and_b32 v234, 0xffff0000, v234
  v_rcp_f32 v237, v234
  v_and_b32 v238, 31, v244
  v_cmp_eq_u32 vcc, 0, v238
  v_mov_b32 v239, 1073741824
  s_nop 0
  v_cndmask_b32 v238, v239, v242, vcc
  buffer_store_dwordx2 v[236:237], v238, s[12:15], s34 offen sc1
  v_mov_b32 v230, -1
  v_mov_b32 v231, -1
  v_mov_b32 v232, -1
  v_mov_b32 v233, -1
  s_mul_i32 s22, s2, 3072
  s_add_u32 s22, s22, 23134208
  s_lshl_b32 s23, s20, 10
  s_add_u32 s22, s22, s23
  s_cmp_eq_u32 s20, 3
  s_cselect_b32 s22, 1073741824, s22
  v_lshlrev_b32 v234, 4, v244
  buffer_store_dwordx4 v[230:233], v234, s[12:15], s22 offen sc1
  s_lshl_b32 s22, s2, 2
  s_add_u32 s22, s22, s20
  s_lshl_b32 s22, s22, 6
  s_add_u32 s22, s22, 24182784
  v_mov_b32 v235, 0
  v_mov_b32 v236, 1073741824
  v_cmp_eq_u32 vcc, 0, v244
  s_nop 1
  v_cndmask_b32 v236, v236, v235, vcc
  buffer_store_dword v235, v236, s[12:15], s22 offen sc1
  s_waitcnt vmcnt(0)
  s_barrier
  s_lshr_b32 s22, s2, 2
  s_lshl_b32 s22, s22, 2
  s_cmp_eq_u32 s20, 0
  s_cselect_b32 s22, s22, 1073741824
  v_mov_b32 v232, s22
  v_mov_b32 v233, 1073741824
  v_cmp_eq_u32 vcc, 0, v244
  s_nop 1
  v_cndmask_b32 v232, v233, v232, vcc
  v_mov_b32 v233, 1
  buffer_atomic_add v233, v232, s[16:19], 0 offen sc1
  s_and_b32 s23, s32, 3
  s_lshl_b32 s23, s23, 2
  s_add_u32 s23, s23, s20
  v_lshlrev_b32 v234, 4, v244
  v_mov_b32 v230, -1
  v_mov_b32 v231, -1
  v_mov_b32 v232, -1
  v_mov_b32 v233, -1
  s_mul_i32 s22, s23, 606208
  s_add_u32 s22, s22, 55296
  s_mov_b32 s28, 8
L_k1_kernel_spo:
  buffer_store_dwordx4 v[230:233], v234, s[12:15], s22 offen offset:0 sc1
  buffer_store_dwordx4 v[230:233], v234, s[12:15], s22 offen offset:1024 sc1
  buffer_store_dwordx4 v[230:233], v234, s[12:15], s22 offen offset:2048 sc1
  buffer_store_dwordx4 v[230:233], v234, s[12:15], s22 offen offset:3072 sc1
  s_add_u32 s22, s22, 4096
  buffer_store_dwordx4 v[230:233], v234, s[12:15], s22 offen offset:0 sc1
  buffer_store_dwordx4 v[230:233], v234, s[12:15], s22 offen offset:1024 sc1
  buffer_store_dwordx4 v[230:233], v234, s[12:15], s22 offen offset:2048 sc1
  buffer_store_dwordx4 v[230:233], v234, s[12:15], s22 offen offset:3072 sc1
  s_add_u32 s22, s22, 4096
  buffer_store_dwordx4 v[230:233], v234, s[12:15], s22 offen offset:0 sc1
  buffer_store_dwordx4 v[230:233], v234, s[12:15], s22 offen offset:1024 sc1
  buffer_store_dwordx4 v[230:233], v234, s[12:15], s22 offen offset:2048 sc1
  buffer_store_dwordx4 v[230:233], v234, s[12:15], s22 offen offset:3072 sc1
  s_add_u32 s22, s22, 4096
  buffer_store_dwordx4 v[230:233], v234, s[12:15], s22 offen offset:0 sc1
  buffer_store_dwordx4 v[230:233], v234, s[12:15], s22 offen offset:1024 sc1
  buffer_store_dwordx4 v[230:233], v234, s[12:15], s22 offen offset:2048 sc1
  buffer_store_dwordx4 v[230:233], v234, s[12:15], s22 offen offset:3072 sc1
  s_add_u32 s22, s22, 4096
  buffer_store_dwordx4 v[230:233], v234, s[12:15], s22 offen offset:0 sc1
  buffer_store_dwordx4 v[230:233], v234, s[12:15], s22 offen offset:1024 sc1
  buffer_store_dwordx4 v[230:233], v234, s[12:15], s22 offen offset:2048 sc1
  buffer_store_dwordx4 v[230:233], v234, s[12:15], s22 offen offset:3072 sc1
  s_add_u32 s22, s22, 4096
  s_add_u32 s22, s22, 55296
  s_sub_u32 s28, s28, 1
  s_cmp_lg_u32 s28, 0
  s_cbranch_scc1 L_k1_kernel_spo
L_k1_kernel_end:
  s_endpgm
.globl k2_kernel
.p2align 8
.type k2_kernel,@function
k2_kernel:
L_k2_code:
  s_cmp_ge_u32 s2, 256
  s_cbranch_scc1 L_k2_kernel_end
  s_load_dwordx2 s[16:17], s[0:1], 0
  s_load_dwordx2 s[18:19], s[0:1], 56
  s_load_dwordx2 s[20:21], s[0:1], 72
  v_and_b32 v15, 63, v0
  v_lshrrev_b32 v1, 6, v0
  v_mov_b32 v2, 31744
  v_readfirstlane_b32 s52, v1
  v_mov_b32 v4, 0
  v_mov_b32 v5, 0
  v_mov_b32 v6, 0
  v_mov_b32 v7, 0
  ds_write_b128 v2, v[4:7]
  s_and_b32 s26, s2, 7
  s_lshr_b32 s25, s2, 3
  s_lshr_b32 s23, s26, 1
  s_lshl_b32 s27, s23, 3
  s_lshr_b32 s23, s25, 2
  s_add_u32 s27, s27, s23
  s_and_b32 s23, s26, 1
  s_lshl_b32 s28, s23, 2
  s_and_b32 s23, s25, 3
  s_add_u32 s28, s28, s23
  s_lshl_b32 s23, s26, 2
  s_lshr_b32 s24, s25, 3
  s_add_u32 s23, s23, s24
  s_and_b32 s24, s25, 7
  s_cmp_ge_u32 s52, 4
  s_cselect_b32 s46, s23, s25
  s_cselect_b32 s47, s24, s26
  s_mov_b32 s25, s46
  s_mov_b32 s26, s47
  s_and_b32 s29, s25, 1
  s_mul_i32 s30, s25, 5
  s_lshr_b32 s30, s30, 1
  s_and_b32 s38, s28, 1
  s_and_b32 s22, s52, 3
  s_waitcnt lgkmcnt(0)
  s_barrier
  s_add_u32 s8, s20, 0
  s_addc_u32 s9, s21, 0
  s_mov_b32 s10, 268435456
  s_mov_b32 s11, 0x20000
  s_cmp_ge_u32 s52, 4
  s_cbranch_scc1 L_k2_kernel_att
  v_mov_b32 v81, v15
  v_lshlrev_b32 v80, 4, v81
  s_lshl_b32 s32, s22, 10
  s_and_b32 s31, s27, 1
  s_mul_i32 s31, s31, 24576
  s_add_u32 s34, s32, s31
  s_mul_i32 s24, s28, 5
  s_add_u32 s23, s24, s38
  s_mul_i32 s23, s23, 75776
  s_add_u32 s23, s23, 10485760
  s_add_u32 s63, s23, s34
  s_add_u32 s64, s63, 75776
  s_add_u32 s65, s63, 151552
  s_add_u32 s66, s63, 227328
  s_cmp_eq_u32 s38, 1
  s_cselect_b32 s23, 0, 4
  s_add_u32 s23, s23, s24
  s_mul_i32 s23, s23, 75776
  s_add_u32 s23, s23, 10485760
  s_add_u32 s67, s23, s34
  buffer_load_dwordx4 a[84:87], v80, s[8:11], s63 offen
  buffer_load_dwordx4 a[88:91], v80, s[8:11], s64 offen
  buffer_load_dwordx4 v[84:87], v80, s[8:11], s65 offen
  buffer_load_dwordx4 v[88:91], v80, s[8:11], s66 offen
  buffer_load_dwordx4 a[100:103], v80, s[8:11], s67 offen
  s_xor_b32 s24, s27, 1
  s_mul_i32 s24, s24, 303104
  s_add_u32 s24, s24, s34
  s_add_u32 s23, s22, 0
  s_and_b32 s23, s23, 3
  s_mul_i32 s23, s23, 75776
  s_add_u32 s59, s23, s24
  s_add_u32 s23, s22, 1
  s_and_b32 s23, s23, 3
  s_mul_i32 s23, s23, 75776
  s_add_u32 s60, s23, s24
  s_add_u32 s23, s22, 2
  s_and_b32 s23, s23, 3
  s_mul_i32 s23, s23, 75776
  s_add_u32 s61, s23, s24
  s_add_u32 s23, s22, 3
  s_and_b32 s23, s23, 3
  s_mul_i32 s23, s23, 75776
  s_add_u32 s62, s23, s24
  buffer_load_dwordx4 v[92:95], v80, s[8:11], s59 offen
  buffer_load_dwordx4 v[96:99], v80, s[8:11], s60 offen
  buffer_load_dwordx4 v[100:103], v80, s[8:11], s61 offen
  buffer_load_dwordx4 v[104:107], v80, s[8:11], s62 offen
  s_xor_b32 s24, s27, 0
  s_mul_i32 s24, s24, 303104
  s_add_u32 s24, s24, s34
  s_add_u32 s23, s22, 0
  s_and_b32 s23, s23, 3
  s_mul_i32 s23, s23, 75776
  s_add_u32 s55, s23, s24
  s_add_u32 s23, s22, 1
  s_and_b32 s23, s23, 3
  s_mul_i32 s23, s23, 75776
  s_add_u32 s56, s23, s24
  s_add_u32 s23, s22, 2
  s_and_b32 s23, s23, 3
  s_mul_i32 s23, s23, 75776
  s_add_u32 s57, s23, s24
  s_add_u32 s23, s22, 3
  s_and_b32 s23, s23, 3
  s_mul_i32 s23, s23, 75776
  s_add_u32 s58, s23, s24
  buffer_load_dwordx4 v[108:111], v80, s[8:11], s55 offen
  buffer_load_dwordx4 v[112:115], v80, s[8:11], s56 offen
  buffer_load_dwordx4 v[116:119], v80, s[8:11], s57 offen
  buffer_load_dwordx4 a[80:83], v80, s[8:11], s58 offen
  s_barrier
  s_sub_u32 s40, s55, s31
  s_sub_u32 s41, s56, s31
  s_sub_u32 s42, s57, s31
  s_sub_u32 s43, s58, s31
  s_sub_u32 s48, s63, s31
  s_sub_u32 s49, s64, s31
  s_sub_u32 s50, s65, s31
  s_sub_u32 s51, s66, s31
  s_sub_u32 s52, s67, s31
  s_cmp_ge_u32 s22, 2
  s_cselect_b32 s33, 1073741824, 53248
  s_mov_b32 s4, s16
  s_mov_b32 s5, s17
  s_mov_b32 s6, 2621440
  s_mov_b32 s7, 0x20000
  s_mov_b32 s12, s18
  s_mov_b32 s13, s19
  s_mov_b32 s14, 2621440
  s_mov_b32 s15, 0x20000
  s_lshl_b32 s23, s2, 2
  s_add_u32 s23, s23, s22
  s_mul_i32 s47, s23, 2560
  s_add_u32 s47, s47, 27262976
  s_lshl_b32 s69, s23, 6
  s_add_u32 s69, s69, 24182784
  s_xor_b32 s23, s23, 128
  s_mul_i32 s45, s23, 2560
  s_add_u32 s45, s45, 27262976
  s_lshl_b32 s68, s23, 6
  s_add_u32 s68, s68, 24182784
  s_mul_i32 s23, s22, 3072
  s_add_u32 s53, s23, 114688
  v_and_b32 v82, 15, v81
  v_lshrrev_b32 v83, 4, v81
  v_bfe_u32 v144, v82, 1, 2
  v_xor_b32 v144, v144, v83
  v_lshrrev_b32 v83, 3, v82
  v_xor_b32 v144, v144, v83
  v_lshl_add_u32 v144, v82, 2, v144
  v_lshlrev_b32 v82, 4, v144
  s_add_u32 s23, s22, 0
  s_and_b32 s23, s23, 3
  s_mul_i32 s23, s23, 20480
  s_add_u32 s23, s23, 32768
  v_add_u32 v140, s23, v82
  s_add_u32 s23, s22, 1
  s_and_b32 s23, s23, 3
  s_mul_i32 s23, s23, 20480
  s_add_u32 s23, s23, 37888
  v_add_u32 v141, s23, v82
  s_add_u32 s23, s22, 2
  s_and_b32 s23, s23, 3
  s_mul_i32 s23, s23, 20480
  s_add_u32 s23, s23, 43008
  v_add_u32 v142, s23, v82
  s_add_u32 s23, s22, 3
  s_and_b32 s23, s23, 3
  s_mul_i32 s23, s23, 20480
  s_add_u32 s23, s23, 48128
  v_add_u32 v143, s23, v82
  s_mul_i32 s23, s22, 20480
  s_add_u32 s23, s23, 32768
  v_add_u32 v144, s23, v80
  s_lshl_b32 s23, s27, 7
  s_add_u32 s23, s23, 24117248
  v_lshlrev_b32 v82, 2, v81
  v_add_u32 v82, s23, v82
  v_mov_b32 v83, 1073741824
  v_cmp_gt_u32 vcc, 32, v81
  s_nop 1
  v_cndmask_b32 v145, v83, v82, vcc
  v_mov_b32 v82, 0
  v_cmp_eq_u32 vcc, 0, v81
  s_nop 1
  v_cndmask_b32 v147, v83, v82, vcc
  s_add_u32 s44, s63, 4096
  buffer_load_dwordx4 v[132:135], v80, s[8:11], s44 offen
  s_add_u32 s44, s64, 4096
  buffer_load_dwordx4 v[136:139], v80, s[8:11], s44 offen
  s_add_u32 s44, s65, 4096
  buffer_load_dwordx4 a[92:95], v80, s[8:11], s44 offen
  s_add_u32 s44, s66, 4096
  buffer_load_dwordx4 a[96:99], v80, s[8:11], s44 offen
  s_add_u32 s44, s67, 4096
  buffer_load_dwordx4 v[120:123], v80, s[8:11], s44 offen
  s_add_u32 s44, s59, 4096
  buffer_load_dwordx4 a[104:107], v80, s[8:11], s44 offen
  s_add_u32 s44, s60, 4096
  buffer_load_dwordx4 v[124:127], v80, s[8:11], s44 offen
  s_add_u32 s44, s61, 4096
  buffer_load_dwordx4 v[128:131], v80, s[8:11], s44 offen
  s_waitcnt vmcnt(15)
  v_mfma_f32_16x16x32_bf16 a[0:3], a[84:87], v[92:95], 0
  v_mfma_f32_16x16x32_bf16 a[4:7], a[88:91], v[92:95], 0
  v_mfma_f32_16x16x32_bf16 a[8:11], v[84:87], v[92:95], 0
  v_mfma_f32_16x16x32_bf16 a[12:15], v[88:91], v[92:95], 0
  v_mfma_f32_16x16x32_bf16 a[16:19], a[100:103], v[92:95], 0
  s_waitcnt vmcnt(14)
  v_mfma_f32_16x16x32_bf16 a[20:23], a[84:87], v[96:99], 0
  s_add_u32 s44, s62, 4096
  buffer_load_dwordx4 v[92:95], v80, s[8:11], s44 offen
  v_mfma_f32_16x16x32_bf16 a[24:27], a[88:91], v[96:99], 0
  v_mfma_f32_16x16x32_bf16 a[28:31], v[84:87], v[96:99], 0
  v_mfma_f32_16x16x32_bf16 a[32:35], v[88:91], v[96:99], 0
  v_mfma_f32_16x16x32_bf16 a[36:39], a[100:103], v[96:99], 0
  s_waitcnt vmcnt(14)
  v_mfma_f32_16x16x32_bf16 a[40:43], a[84:87], v[100:103], 0
  s_add_u32 s44, s55, 4096
  buffer_load_dwordx4 v[96:99], v80, s[8:11], s44 offen
  v_mfma_f32_16x16x32_bf16 a[44:47], a[88:91], v[100:103], 0
  v_mfma_f32_16x16x32_bf16 a[48:51], v[84:87], v[100:103], 0
  v_mfma_f32_16x16x32_bf16 a[52:55], v[88:91], v[100:103], 0
  v_mfma_f32_16x16x32_bf16 a[56:59], a[100:103], v[100:103], 0
  s_waitcnt vmcnt(14)
  v_mfma_f32_16x16x32_bf16 a[60:63], a[84:87], v[104:107], 0
  s_add_u32 s44, s56, 4096
  buffer_load_dwordx4 v[100:103], v80, s[8:11], s44 offen
  v_mfma_f32_16x16x32_bf16 a[64:67], a[88:91], v[104:107], 0
  v_mfma_f32_16x16x32_bf16 a[68:71], v[84:87], v[104:107], 0
  v_mfma_f32_16x16x32_bf16 a[72:75], v[88:91], v[104:107], 0
  v_mfma_f32_16x16x32_bf16 a[76:79], a[100:103], v[104:107], 0
  s_waitcnt vmcnt(14)
  v_mfma_f32_16x16x32_bf16 v[0:3], a[84:87], v[108:111], 0
  s_add_u32 s44, s57, 4096
  buffer_load_dwordx4 v[104:107], v80, s[8:11], s44 offen
  v_mfma_f32_16x16x32_bf16 v[4:7], a[88:91], v[108:111], 0
  v_mfma_f32_16x16x32_bf16 v[8:11], v[84:87], v[108:111], 0
  v_mfma_f32_16x16x32_bf16 v[12:15], v[88:91], v[108:111], 0
  v_mfma_f32_16x16x32_bf16 v[16:19], a[100:103], v[108:111], 0
  s_waitcnt vmcnt(14)
  v_mfma_f32_16x16x32_bf16 v[20:23], a[84:87], v[112:115], 0
  s_add_u32 s44, s58, 4096
  buffer_load_dwordx4 v[108:111], v80, s[8:11], s44 offen
  v_mfma_f32_16x16x32_bf16 v[24:27], a[88:91], v[112:115], 0
  v_mfma_f32_16x16x32_bf16 v[28:31], v[84:87], v[112:115], 0
  v_mfma_f32_16x16x32_bf16 v[32:35], v[88:91], v[112:115], 0
  v_mfma_f32_16x16x32_bf16 v[36:39], a[100:103], v[112:115], 0
  s_waitcnt vmcnt(14)
  v_mfma_f32_16x16x32_bf16 v[40:43], a[84:87], v[116:119], 0
  s_add_u32 s44, s63, 8192
  buffer_load_dwordx4 v[112:115], v80, s[8:11], s44 offen
  v_mfma_f32_16x16x32_bf16 v[44:47], a[88:91], v[116:119], 0
  v_mfma_f32_16x16x32_bf16 v[48:51], v[84:87], v[116:119], 0
  v_mfma_f32_16x16x32_bf16 v[52:55], v[88:91], v[116:119], 0
  v_mfma_f32_16x16x32_bf16 v[56:59], a[100:103], v[116:119], 0
  s_waitcnt vmcnt(14)
  v_mfma_f32_16x16x32_bf16 v[60:63], a[84:87], a[80:83], 0
  s_add_u32 s44, s64, 8192
  buffer_load_dwordx4 v[116:119], v80, s[8:11], s44 offen
  v_mfma_f32_16x16x32_bf16 v[64:67], a[88:91], a[80:83], 0
  v_mfma_f32_16x16x32_bf16 v[68:71], v[84:87], a[80:83], 0
  v_mfma_f32_16x16x32_bf16 v[72:75], v[88:91], a[80:83], 0
  v_mfma_f32_16x16x32_bf16 v[76:79], a[100:103], a[80:83], 0
  s_waitcnt vmcnt(9)
  v_mfma_f32_16x16x32_bf16 a[0:3], v[132:135], a[104:107], a[0:3]
  s_add_u32 s44, s65, 8192
  buffer_load_dwordx4 a[80:83], v80, s[8:11], s44 offen
  s_add_u32 s44, s66, 8192
  buffer_load_dwordx4 a[84:87], v80, s[8:11], s44 offen
  v_mfma_f32_16x16x32_bf16 a[4:7], v[136:139], a[104:107], a[4:7]
  s_add_u32 s44, s67, 8192
  buffer_load_dwordx4 a[88:91], v80, s[8:11], s44 offen
  v_mfma_f32_16x16x32_bf16 a[8:11], a[92:95], a[104:107], a[8:11]
  s_add_u32 s44, s59, 8192
  buffer_load_dwordx4 v[84:87], v80, s[8:11], s44 offen
  s_add_u32 s44, s60, 8192
  buffer_load_dwordx4 v[88:91], v80, s[8:11], s44 offen
  v_mfma_f32_16x16x32_bf16 a[12:15], a[96:99], a[104:107], a[12:15]
  s_add_u32 s44, s61, 8192
  buffer_load_dwordx4 a[100:103], v80, s[8:11], s44 offen
  v_mfma_f32_16x16x32_bf16 a[16:19], v[120:123], a[104:107], a[16:19]
  s_waitcnt vmcnt(14)
  v_mfma_f32_16x16x32_bf16 a[20:23], v[132:135], v[124:127], a[20:23]
  s_add_u32 s44, s62, 8192
  buffer_load_dwordx4 a[104:107], v80, s[8:11], s44 offen
  v_mfma_f32_16x16x32_bf16 a[24:27], v[136:139], v[124:127], a[24:27]
  v_mfma_f32_16x16x32_bf16 a[28:31], a[92:95], v[124:127], a[28:31]
  v_mfma_f32_16x16x32_bf16 a[32:35], a[96:99], v[124:127], a[32:35]
  v_mfma_f32_16x16x32_bf16 a[36:39], v[120:123], v[124:127], a[36:39]
  s_waitcnt vmcnt(14)
  v_mfma_f32_16x16x32_bf16 a[40:43], v[132:135], v[128:131], a[40:43]
  s_add_u32 s44, s55, 8192
  buffer_load_dwordx4 v[124:127], v80, s[8:11], s44 offen
  v_mfma_f32_16x16x32_bf16 a[44:47], v[136:139], v[128:131], a[44:47]
  v_mfma_f32_16x16x32_bf16 a[48:51], a[92:95], v[128:131], a[48:51]
  v_mfma_f32_16x16x32_bf16 a[52:55], a[96:99], v[128:131], a[52:55]
  v_mfma_f32_16x16x32_bf16 a[56:59], v[120:123], v[128:131], a[56:59]
  s_waitcnt vmcnt(14)
  v_mfma_f32_16x16x32_bf16 a[60:63], v[132:135], v[92:95], a[60:63]
  s_add_u32 s44, s56, 8192
  buffer_load_dwordx4 v[128:131], v80, s[8:11], s44 offen
  v_mfma_f32_16x16x32_bf16 a[64:67], v[136:139], v[92:95], a[64:67]
  v_mfma_f32_16x16x32_bf16 a[68:71], a[92:95], v[92:95], a[68:71]
  v_mfma_f32_16x16x32_bf16 a[72:75], a[96:99], v[92:95], a[72:75]
  v_mfma_f32_16x16x32_bf16 a[76:79], v[120:123], v[92:95], a[76:79]
  s_waitcnt vmcnt(14)
  v_mfma_f32_16x16x32_bf16 v[0:3], v[132:135], v[96:99], v[0:3]
  s_add_u32 s44, s57, 8192
  buffer_load_dwordx4 v[92:95], v80, s[8:11], s44 offen
  v_mfma_f32_16x16x32_bf16 v[4:7], v[136:139], v[96:99], v[4:7]
  v_mfma_f32_16x16x32_bf16 v[8:11], a[92:95], v[96:99], v[8:11]
  v_mfma_f32_16x16x32_bf16 v[12:15], a[96:99], v[96:99], v[12:15]
  v_mfma_f32_16x16x32_bf16 v[16:19], v[120:123], v[96:99], v[16:19]
  s_waitcnt vmcnt(14)
  v_mfma_f32_16x16x32_bf16 v[20:23], v[132:135], v[100:103], v[20:23]
  s_add_u32 s44, s58, 8192
  buffer_load_dwordx4 v[96:99], v80, s[8:11], s44 offen
  v_mfma_f32_16x16x32_bf16 v[24:27], v[136:139], v[100:103], v[24:27]
  v_mfma_f32_16x16x32_bf16 v[28:31], a[92:95], v[100:103], v[28:31]
  v_mfma_f32_16x16x32_bf16 v[32:35], a[96:99], v[100:103], v[32:35]
  v_mfma_f32_16x16x32_bf16 v[36:39], v[120:123], v[100:103], v[36:39]
  s_waitcnt vmcnt(14)
  v_mfma_f32_16x16x32_bf16 v[40:43], v[132:135], v[104:107], v[40:43]
  s_add_u32 s44, s63, 12288
  buffer_load_dwordx4 v[100:103], v80, s[8:11], s44 offen
  v_mfma_f32_16x16x32_bf16 v[44:47], v[136:139], v[104:107], v[44:47]
  v_mfma_f32_16x16x32_bf16 v[48:51], a[92:95], v[104:107], v[48:51]
  v_mfma_f32_16x16x32_bf16 v[52:55], a[96:99], v[104:107], v[52:55]
  v_mfma_f32_16x16x32_bf16 v[56:59], v[120:123], v[104:107], v[56:59]
  s_waitcnt vmcnt(14)
  v_mfma_f32_16x16x32_bf16 v[60:63], v[132:135], v[108:111], v[60:63]
  s_add_u32 s44, s64, 12288
  buffer_load_dwordx4 v[104:107], v80, s[8:11], s44 offen
  v_mfma_f32_16x16x32_bf16 v[64:67], v[136:139], v[108:111], v[64:67]
  v_mfma_f32_16x16x32_bf16 v[68:71], a[92:95], v[108:111], v[68:71]
  v_mfma_f32_16x16x32_bf16 v[72:75], a[96:99], v[108:111], v[72:75]
  v_mfma_f32_16x16x32_bf16 v[76:79], v[120:123], v[108:111], v[76:79]
  s_waitcnt vmcnt(9)
  v_mfma_f32_16x16x32_bf16 a[0:3], v[112:115], v[84:87], a[0:3]
  s_add_u32 s44, s65, 12288
  buffer_load_dwordx4 v[108:111], v80, s[8:11], s44 offen
  s_add_u32 s44, s66, 12288
  buffer_load_dwordx4 v[132:135], v80, s[8:11], s44 offen
  v_mfma_f32_16x16x32_bf16 a[4:7], v[116:119], v[84:87], a[4:7]
  s_add_u32 s44, s67, 12288
  buffer_load_dwordx4 v[136:139], v80, s[8:11], s44 offen
  v_mfma_f32_16x16x32_bf16 a[8:11], a[80:83], v[84:87], a[8:11]
  s_add_u32 s44, s59, 12288
  buffer_load_dwordx4 a[92:95], v80, s[8:11], s44 offen
  s_add_u32 s44, s60, 12288
  buffer_load_dwordx4 a[96:99], v80, s[8:11], s44 offen
  v_mfma_f32_16x16x32_bf16 a[12:15], a[84:87], v[84:87], a[12:15]
  s_add_u32 s44, s61, 12288
  buffer_load_dwordx4 v[120:123], v80, s[8:11], s44 offen
  v_mfma_f32_16x16x32_bf16 a[16:19], a[88:91], v[84:87], a[16:19]
  s_waitcnt vmcnt(14)
  v_mfma_f32_16x16x32_bf16 a[20:23], v[112:115], v[88:91], a[20:23]
  s_add_u32 s44, s62, 12288
  buffer_load_dwordx4 v[84:87], v80, s[8:11], s44 offen
  v_mfma_f32_16x16x32_bf16 a[24:27], v[116:119], v[88:91], a[24:27]
  v_mfma_f32_16x16x32_bf16 a[28:31], a[80:83], v[88:91], a[28:31]
  v_mfma_f32_16x16x32_bf16 a[32:35], a[84:87], v[88:91], a[32:35]
  v_mfma_f32_16x16x32_bf16 a[36:39], a[88:91], v[88:91], a[36:39]
  s_waitcnt vmcnt(14)
  v_mfma_f32_16x16x32_bf16 a[40:43], v[112:115], a[100:103], a[40:43]
  s_add_u32 s44, s55, 12288
  buffer_load_dwordx4 v[88:91], v80, s[8:11], s44 offen
  v_mfma_f32_16x16x32_bf16 a[44:47], v[116:119], a[100:103], a[44:47]
  v_mfma_f32_16x16x32_bf16 a[48:51], a[80:83], a[100:103], a[48:51]
  v_mfma_f32_16x16x32_bf16 a[52:55], a[84:87], a[100:103], a[52:55]
  v_mfma_f32_16x16x32_bf16 a[56:59], a[88:91], a[100:103], a[56:59]
  s_waitcnt vmcnt(14)
  v_mfma_f32_16x16x32_bf16 a[60:63], v[112:115], a[104:107], a[60:63]
  s_add_u32 s44, s56, 12288
  buffer_load_dwordx4 a[100:103], v80, s[8:11], s44 offen
  v_mfma_f32_16x16x32_bf16 a[64:67], v[116:119], a[104:107], a[64:67]
  v_mfma_f32_16x16x32_bf16 a[68:71], a[80:83], a[104:107], a[68:71]
  v_mfma_f32_16x16x32_bf16 a[72:75], a[84:87], a[104:107], a[72:75]
  v_mfma_f32_16x16x32_bf16 a[76:79], a[88:91], a[104:107], a[76:79]
  s_waitcnt vmcnt(14)
  v_mfma_f32_16x16x32_bf16 v[0:3], v[112:115], v[124:127], v[0:3]
  s_add_u32 s44, s57, 12288
  buffer_load_dwordx4 a[104:107], v80, s[8:11], s44 offen
  v_mfma_f32_16x16x32_bf16 v[4:7], v[116:119], v[124:127], v[4:7]
  v_mfma_f32_16x16x32_bf16 v[8:11], a[80:83], v[124:127], v[8:11]
  v_mfma_f32_16x16x32_bf16 v[12:15], a[84:87], v[124:127], v[12:15]
  v_mfma_f32_16x16x32_bf16 v[16:19], a[88:91], v[124:127], v[16:19]
  s_waitcnt vmcnt(14)
  v_mfma_f32_16x16x32_bf16 v[20:23], v[112:115], v[128:131], v[20:23]
  s_add_u32 s44, s58, 12288
  buffer_load_dwordx4 v[124:127], v80, s[8:11], s44 offen
  v_mfma_f32_16x16x32_bf16 v[24:27], v[116:119], v[128:131], v[24:27]
  v_mfma_f32_16x16x32_bf16 v[28:31], a[80:83], v[128:131], v[28:31]
  v_mfma_f32_16x16x32_bf16 v[32:35], a[84:87], v[128:131], v[32:35]
  v_mfma_f32_16x16x32_bf16 v[36:39], a[88:91], v[128:131], v[36:39]
  s_waitcnt vmcnt(14)
  v_mfma_f32_16x16x32_bf16 v[40:43], v[112:115], v[92:95], v[40:43]
  s_add_u32 s44, s63, 16384
  buffer_load_dwordx4 v[128:131], v80, s[8:11], s44 offen
  v_mfma_f32_16x16x32_bf16 v[44:47], v[116:119], v[92:95], v[44:47]
  v_mfma_f32_16x16x32_bf16 v[48:51], a[80:83], v[92:95], v[48:51]
  v_mfma_f32_16x16x32_bf16 v[52:55], a[84:87], v[92:95], v[52:55]
  v_mfma_f32_16x16x32_bf16 v[56:59], a[88:91], v[92:95], v[56:59]
  s_waitcnt vmcnt(14)
  v_mfma_f32_16x16x32_bf16 v[60:63], v[112:115], v[96:99], v[60:63]
  s_add_u32 s44, s64, 16384
  buffer_load_dwordx4 v[92:95], v80, s[8:11], s44 offen
  v_mfma_f32_16x16x32_bf16 v[64:67], v[116:119], v[96:99], v[64:67]
  v_mfma_f32_16x16x32_bf16 v[68:71], a[80:83], v[96:99], v[68:71]
  v_mfma_f32_16x16x32_bf16 v[72:75], a[84:87], v[96:99], v[72:75]
  v_mfma_f32_16x16x32_bf16 v[76:79], a[88:91], v[96:99], v[76:79]
  s_waitcnt vmcnt(9)
  v_mfma_f32_16x16x32_bf16 a[0:3], v[100:103], a[92:95], a[0:3]
  s_add_u32 s44, s65, 16384
  buffer_load_dwordx4 v[96:99], v80, s[8:11], s44 offen
  s_add_u32 s44, s66, 16384
  buffer_load_dwordx4 v[112:115], v80, s[8:11], s44 offen
  v_mfma_f32_16x16x32_bf16 a[4:7], v[104:107], a[92:95], a[4:7]
  s_add_u32 s44, s67, 16384
  buffer_load_dwordx4 v[116:119], v80, s[8:11], s44 offen
  v_mfma_f32_16x16x32_bf16 a[8:11], v[108:111], a[92:95], a[8:11]
  s_add_u32 s44, s59, 16384
  buffer_load_dwordx4 a[80:83], v80, s[8:11], s44 offen
  s_add_u32 s44, s60, 16384
  buffer_load_dwordx4 a[84:87], v80, s[8:11], s44 offen
  v_mfma_f32_16x16x32_bf16 a[12:15], v[132:135], a[92:95], a[12:15]
  s_add_u32 s44, s61, 16384
  buffer_load_dwordx4 a[88:91], v80, s[8:11], s44 offen
  v_mfma_f32_16x16x32_bf16 a[16:19], v[136:139], a[92:95], a[16:19]
  s_waitcnt vmcnt(14)
  v_mfma_f32_16x16x32_bf16 a[20:23], v[100:103], a[96:99], a[20:23]
  s_add_u32 s44, s62, 16384
  buffer_load_dwordx4 a[92:95], v80, s[8:11], s44 offen
  v_mfma_f32_16x16x32_bf16 a[24:27], v[104:107], a[96:99], a[24:27]
  v_mfma_f32_16x16x32_bf16 a[28:31], v[108:111], a[96:99], a[28:31]
  v_mfma_f32_16x16x32_bf16 a[32:35], v[132:135], a[96:99], a[32:35]
  v_mfma_f32_16x16x32_bf16 a[36:39], v[136:139], a[96:99], a[36:39]
  s_waitcnt vmcnt(14)
  v_mfma_f32_16x16x32_bf16 a[40:43], v[100:103], v[120:123], a[40:43]
  s_add_u32 s44, s55, 16384
  buffer_load_dwordx4 a[96:99], v80, s[8:11], s44 offen
  v_mfma_f32_16x16x32_bf16 a[44:47], v[104:107], v[120:123], a[44:47]
  v_mfma_f32_16x16x32_bf16 a[48:51], v[108:111], v[120:123], a[48:51]
  v_mfma_f32_16x16x32_bf16 a[52:55], v[132:135], v[120:123], a[52:55]
  v_mfma_f32_16x16x32_bf16 a[56:59], v[136:139], v[120:123], a[56:59]
  s_waitcnt vmcnt(14)
  v_mfma_f32_16x16x32_bf16 a[60:63], v[100:103], v[84:87], a[60:63]
  s_add_u32 s44, s56, 16384
  buffer_load_dwordx4 v[120:123], v80, s[8:11], s44 offen
  v_mfma_f32_16x16x32_bf16 a[64:67], v[104:107], v[84:87], a[64:67]
  v_mfma_f32_16x16x32_bf16 a[68:71], v[108:111], v[84:87], a[68:71]
  v_mfma_f32_16x16x32_bf16 a[72:75], v[132:135], v[84:87], a[72:75]
  v_mfma_f32_16x16x32_bf16 a[76:79], v[136:139], v[84:87], a[76:79]
  s_waitcnt vmcnt(14)
  v_mfma_f32_16x16x32_bf16 v[0:3], v[100:103], v[88:91], v[0:3]
  s_add_u32 s44, s57, 16384
  buffer_load_dwordx4 v[84:87], v80, s[8:11], s44 offen
  v_mfma_f32_16x16x32_bf16 v[4:7], v[104:107], v[88:91], v[4:7]
  v_mfma_f32_16x16x32_bf16 v[8:11], v[108:111], v[88:91], v[8:11]
  v_mfma_f32_16x16x32_bf16 v[12:15], v[132:135], v[88:91], v[12:15]
  v_mfma_f32_16x16x32_bf16 v[16:19], v[136:139], v[88:91], v[16:19]
  s_waitcnt vmcnt(14)
  v_mfma_f32_16x16x32_bf16 v[20:23], v[100:103], a[100:103], v[20:23]
  s_add_u32 s44, s58, 16384
  buffer_load_dwordx4 v[88:91], v80, s[8:11], s44 offen
  v_mfma_f32_16x16x32_bf16 v[24:27], v[104:107], a[100:103], v[24:27]
  v_mfma_f32_16x16x32_bf16 v[28:31], v[108:111], a[100:103], v[28:31]
  v_mfma_f32_16x16x32_bf16 v[32:35], v[132:135], a[100:103], v[32:35]
  v_mfma_f32_16x16x32_bf16 v[36:39], v[136:139], a[100:103], v[36:39]
  s_waitcnt vmcnt(14)
  v_mfma_f32_16x16x32_bf16 v[40:43], v[100:103], a[104:107], v[40:43]
  s_add_u32 s44, s63, 20480
  buffer_load_dwordx4 a[100:103], v80, s[8:11], s44 offen
  v_mfma_f32_16x16x32_bf16 v[44:47], v[104:107], a[104:107], v[44:47]
  v_mfma_f32_16x16x32_bf16 v[48:51], v[108:111], a[104:107], v[48:51]
  v_mfma_f32_16x16x32_bf16 v[52:55], v[132:135], a[104:107], v[52:55]
  v_mfma_f32_16x16x32_bf16 v[56:59], v[136:139], a[104:107], v[56:59]
  s_waitcnt vmcnt(14)
  v_mfma_f32_16x16x32_bf16 v[60:63], v[100:103], v[124:127], v[60:63]
  s_add_u32 s44, s64, 20480
  buffer_load_dwordx4 a[104:107], v80, s[8:11], s44 offen
  v_mfma_f32_16x16x32_bf16 v[64:67], v[104:107], v[124:127], v[64:67]
  v_mfma_f32_16x16x32_bf16 v[68:71], v[108:111], v[124:127], v[68:71]
  v_mfma_f32_16x16x32_bf16 v[72:75], v[132:135], v[124:127], v[72:75]
  v_mfma_f32_16x16x32_bf16 v[76:79], v[136:139], v[124:127], v[76:79]
  s_waitcnt vmcnt(9)
  v_mfma_f32_16x16x32_bf16 a[0:3], v[128:131], a[80:83], a[0:3]
  s_add_u32 s44, s65, 20480
  buffer_load_dwordx4 v[124:127], v80, s[8:11], s44 offen
  s_add_u32 s44, s66, 20480
  buffer_load_dwordx4 v[100:103], v80, s[8:11], s44 offen
  v_mfma_f32_16x16x32_bf16 a[4:7], v[92:95], a[80:83], a[4:7]
  s_add_u32 s44, s67, 20480
  buffer_load_dwordx4 v[104:107], v80, s[8:11], s44 offen
  v_mfma_f32_16x16x32_bf16 a[8:11], v[96:99], a[80:83], a[8:11]
  s_add_u32 s44, s59, 20480
  buffer_load_dwordx4 v[108:111], v80, s[8:11], s44 offen
  s_add_u32 s44, s60, 20480
  buffer_load_dwordx4 v[132:135], v80, s[8:11], s44 offen
  v_mfma_f32_16x16x32_bf16 a[12:15], v[112:115], a[80:83], a[12:15]
  s_add_u32 s44, s61, 20480
  buffer_load_dwordx4 v[136:139], v80, s[8:11], s44 offen
  v_mfma_f32_16x16x32_bf16 a[16:19], v[116:119], a[80:83], a[16:19]
  s_waitcnt vmcnt(14)
  v_mfma_f32_16x16x32_bf16 a[20:23], v[128:131], a[84:87], a[20:23]
  s_add_u32 s44, s62, 20480
  buffer_load_dwordx4 a[80:83], v80, s[8:11], s44 offen
  v_mfma_f32_16x16x32_bf16 a[24:27], v[92:95], a[84:87], a[24:27]
  v_mfma_f32_16x16x32_bf16 a[28:31], v[96:99], a[84:87], a[28:31]
  v_mfma_f32_16x16x32_bf16 a[32:35], v[112:115], a[84:87], a[32:35]
  v_mfma_f32_16x16x32_bf16 a[36:39], v[116:119], a[84:87], a[36:39]
  s_waitcnt vmcnt(14)
  v_mfma_f32_16x16x32_bf16 a[40:43], v[128:131], a[88:91], a[40:43]
  s_add_u32 s44, s55, 20480
  buffer_load_dwordx4 a[84:87], v80, s[8:11], s44 offen
  v_mfma_f32_16x16x32_bf16 a[44:47], v[92:95], a[88:91], a[44:47]
  v_mfma_f32_16x16x32_bf16 a[48:51], v[96:99], a[88:91], a[48:51]
  v_mfma_f32_16x16x32_bf16 a[52:55], v[112:115], a[88:91], a[52:55]
  v_mfma_f32_16x16x32_bf16 a[56:59], v[116:119], a[88:91], a[56:59]
  s_waitcnt vmcnt(14)
  v_mfma_f32_16x16x32_bf16 a[60:63], v[128:131], a[92:95], a[60:63]
  s_add_u32 s44, s56, 20480
  buffer_load_dwordx4 a[88:91], v80, s[8:11], s44 offen
  v_mfma_f32_16x16x32_bf16 a[64:67], v[92:95], a[92:95], a[64:67]
  v_mfma_f32_16x16x32_bf16 a[68:71], v[96:99], a[92:95], a[68:71]
  v_mfma_f32_16x16x32_bf16 a[72:75], v[112:115], a[92:95], a[72:75]
  v_mfma_f32_16x16x32_bf16 a[76:79], v[116:119], a[92:95], a[76:79]
  s_waitcnt vmcnt(14)
  v_mfma_f32_16x16x32_bf16 v[0:3], v[128:131], a[96:99], v[0:3]
  s_add_u32 s44, s57, 20480
  buffer_load_dwordx4 a[92:95], v80, s[8:11], s44 offen
  v_mfma_f32_16x16x32_bf16 v[4:7], v[92:95], a[96:99], v[4:7]
  v_mfma_f32_16x16x32_bf16 v[8:11], v[96:99], a[96:99], v[8:11]
  v_mfma_f32_16x16x32_bf16 v[12:15], v[112:115], a[96:99], v[12:15]
  v_mfma_f32_16x16x32_bf16 v[16:19], v[116:119], a[96:99], v[16:19]
  s_waitcnt vmcnt(14)
  v_mfma_f32_16x16x32_bf16 v[20:23], v[128:131], v[120:123], v[20:23]
  s_add_u32 s44, s58, 20480
  buffer_load_dwordx4 a[96:99], v80, s[8:11], s44 offen
  v_mfma_f32_16x16x32_bf16 v[24:27], v[92:95], v[120:123], v[24:27]
  v_mfma_f32_16x16x32_bf16 v[28:31], v[96:99], v[120:123], v[28:31]
  v_mfma_f32_16x16x32_bf16 v[32:35], v[112:115], v[120:123], v[32:35]
  v_mfma_f32_16x16x32_bf16 v[36:39], v[116:119], v[120:123], v[36:39]
  s_waitcnt vmcnt(14)
  v_mfma_f32_16x16x32_bf16 v[40:43], v[128:131], v[84:87], v[40:43]
  s_add_u32 s44, s48, 49152
  buffer_load_dwordx4 v[120:123], v80, s[8:11], s44 offen
  v_mfma_f32_16x16x32_bf16 v[44:47], v[92:95], v[84:87], v[44:47]
  v_mfma_f32_16x16x32_bf16 v[48:51], v[96:99], v[84:87], v[48:51]
  v_mfma_f32_16x16x32_bf16 v[52:55], v[112:115], v[84:87], v[52:55]
  v_mfma_f32_16x16x32_bf16 v[56:59], v[116:119], v[84:87], v[56:59]
  s_waitcnt vmcnt(14)
  v_mfma_f32_16x16x32_bf16 v[60:63], v[128:131], v[88:91], v[60:63]
  s_add_u32 s44, s40, 49152
  buffer_load_dwordx4 v[84:87], v80, s[8:11], s44 offen
  v_mfma_f32_16x16x32_bf16 v[64:67], v[92:95], v[88:91], v[64:67]
  v_mfma_f32_16x16x32_bf16 v[68:71], v[96:99], v[88:91], v[68:71]
  v_mfma_f32_16x16x32_bf16 v[72:75], v[112:115], v[88:91], v[72:75]
  v_mfma_f32_16x16x32_bf16 v[76:79], v[116:119], v[88:91], v[76:79]
  s_waitcnt vmcnt(9)
  v_mfma_f32_16x16x32_bf16 a[0:3], a[100:103], v[108:111], a[0:3]
  s_add_u32 s44, s41, 49152
  buffer_load_dwordx4 v[88:91], v80, s[8:11], s44 offen
  s_add_u32 s44, s42, 49152
  buffer_load_dwordx4 v[128:131], v80, s[8:11], s44 offen
  v_mfma_f32_16x16x32_bf16 a[4:7], a[104:107], v[108:111], a[4:7]
  s_add_u32 s44, s43, 49152
  buffer_load_dwordx4 v[92:95], v80, s[8:11], s44 offen
  v_mfma_f32_16x16x32_bf16 a[8:11], v[124:127], v[108:111], a[8:11]
  s_add_u32 s44, s49, 49152
  buffer_load_dwordx4 v[96:99], v80, s[8:11], s44 offen
  s_add_u32 s44, s50, 49152
  buffer_load_dwordx4 v[112:115], v80, s[8:11], s44 offen
  v_mfma_f32_16x16x32_bf16 a[12:15], v[100:103], v[108:111], a[12:15]
  s_add_u32 s44, s51, 49152
  buffer_load_dwordx4 v[116:119], v80, s[8:11], s44 offen
  v_mfma_f32_16x16x32_bf16 a[16:19], v[104:107], v[108:111], a[16:19]
  s_waitcnt vmcnt(14)
  v_mfma_f32_16x16x32_bf16 a[20:23], a[100:103], v[132:135], a[20:23]
  s_add_u32 s44, s52, 49152
  buffer_load_dwordx4 v[108:111], v80, s[8:11], s44 offen
  v_mfma_f32_16x16x32_bf16 a[24:27], a[104:107], v[132:135], a[24:27]
  v_mfma_f32_16x16x32_bf16 a[28:31], v[124:127], v[132:135], a[28:31]
  v_mfma_f32_16x16x32_bf16 a[32:35], v[100:103], v[132:135], a[32:35]
  v_mfma_f32_16x16x32_bf16 a[36:39], v[104:107], v[132:135], a[36:39]
  s_waitcnt vmcnt(14)
  v_mfma_f32_16x16x32_bf16 a[40:43], a[100:103], v[136:139], a[40:43]
  s_add_u32 s44, s48, s33
  buffer_load_dwordx4 v[132:135], v80, s[8:11], s44 offen
  v_mfma_f32_16x16x32_bf16 a[44:47], a[104:107], v[136:139], a[44:47]
  ds_write_b128 v140, a[0:3] offset:0
  v_mfma_f32_16x16x32_bf16 a[48:51], v[124:127], v[136:139], a[48:51]
  ds_write_b128 v140, a[4:7] offset:1024
  v_mfma_f32_16x16x32_bf16 a[52:55], v[100:103], v[136:139], a[52:55]
  ds_write_b128 v140, a[8:11] offset:2048
  v_mfma_f32_16x16x32_bf16 a[56:59], v[104:107], v[136:139], a[56:59]
  s_waitcnt vmcnt(14)
  v_mfma_f32_16x16x32_bf16 a[60:63], a[100:103], a[80:83], a[60:63]
  s_add_u32 s44, s40, s33
  buffer_load_dwordx4 v[136:139], v80, s[8:11], s44 offen
  v_mfma_f32_16x16x32_bf16 a[64:67], a[104:107], a[80:83], a[64:67]
  ds_write_b128 v140, a[12:15] offset:3072
  v_mfma_f32_16x16x32_bf16 a[68:71], v[124:127], a[80:83], a[68:71]
  ds_write_b128 v140, a[16:19] offset:4096
  v_mfma_f32_16x16x32_bf16 a[72:75], v[100:103], a[80:83], a[72:75]
  ds_write_b128 v141, a[20:23] offset:0
  v_mfma_f32_16x16x32_bf16 a[76:79], v[104:107], a[80:83], a[76:79]
  s_waitcnt vmcnt(14)
  v_mfma_f32_16x16x32_bf16 v[0:3], a[100:103], a[84:87], v[0:3]
  s_add_u32 s44, s41, s33
  buffer_load_dwordx4 a[80:83], v80, s[8:11], s44 offen
  v_mfma_f32_16x16x32_bf16 v[4:7], a[104:107], a[84:87], v[4:7]
  ds_write_b128 v141, a[24:27] offset:1024
  v_mfma_f32_16x16x32_bf16 v[8:11], v[124:127], a[84:87], v[8:11]
  ds_write_b128 v141, a[28:31] offset:2048
  v_mfma_f32_16x16x32_bf16 v[12:15], v[100:103], a[84:87], v[12:15]
  ds_write_b128 v141, a[32:35] offset:3072
  v_mfma_f32_16x16x32_bf16 v[16:19], v[104:107], a[84:87], v[16:19]
  s_waitcnt vmcnt(14)
  v_mfma_f32_16x16x32_bf16 v[20:23], a[100:103], a[88:91], v[20:23]
  s_add_u32 s44, s42, s33
  buffer_load_dwordx4 a[84:87], v80, s[8:11], s44 offen
  v_mfma_f32_16x16x32_bf16 v[24:27], a[104:107], a[88:91], v[24:27]
  ds_write_b128 v141, a[36:39] offset:4096
  v_mfma_f32_16x16x32_bf16 v[28:31], v[124:127], a[88:91], v[28:31]
  ds_write_b128 v142, a[40:43] offset:0
  v_mfma_f32_16x16x32_bf16 v[32:35], v[100:103], a[88:91], v[32:35]
  ds_write_b128 v142, a[44:47] offset:1024
  v_mfma_f32_16x16x32_bf16 v[36:39], v[104:107], a[88:91], v[36:39]
  s_waitcnt vmcnt(14)
  v_mfma_f32_16x16x32_bf16 v[40:43], a[100:103], a[92:95], v[40:43]
  s_add_u32 s44, s43, s33
  buffer_load_dwordx4 a[88:91], v80, s[8:11], s44 offen
  v_mfma_f32_16x16x32_bf16 v[44:47], a[104:107], a[92:95], v[44:47]
  ds_write_b128 v142, a[48:51] offset:2048
  v_mfma_f32_16x16x32_bf16 v[48:51], v[124:127], a[92:95], v[48:51]
  ds_write_b128 v142, a[52:55] offset:3072
  v_mfma_f32_16x16x32_bf16 v[52:55], v[100:103], a[92:95], v[52:55]
  ds_write_b128 v142, a[56:59] offset:4096
  v_mfma_f32_16x16x32_bf16 v[56:59], v[104:107], a[92:95], v[56:59]
  s_waitcnt vmcnt(14)
  v_mfma_f32_16x16x32_bf16 v[60:63], a[100:103], a[96:99], v[60:63]
  s_add_u32 s44, s49, s33
  buffer_load_dwordx4 a[92:95], v80, s[8:11], s44 offen
  v_mfma_f32_16x16x32_bf16 v[64:67], a[104:107], a[96:99], v[64:67]
  ds_write_b128 v143, a[60:63] offset:0
  v_mfma_f32_16x16x32_bf16 v[68:71], v[124:127], a[96:99], v[68:71]
  ds_write_b128 v143, a[64:67] offset:1024
  v_mfma_f32_16x16x32_bf16 v[72:75], v[100:103], a[96:99], v[72:75]
  ds_write_b128 v143, a[68:71] offset:2048
  v_mfma_f32_16x16x32_bf16 v[76:79], v[104:107], a[96:99], v[76:79]
  s_waitcnt vmcnt(13)
  v_mfma_f32_16x16x32_bf16 v[0:3], v[120:123], v[84:87], v[0:3]
  s_add_u32 s44, s50, s33
  buffer_load_dwordx4 a[96:99], v80, s[8:11], s44 offen
  s_add_u32 s44, s51, s33
  buffer_load_dwordx4 a[100:103], v80, s[8:11], s44 offen
  s_waitcnt vmcnt(14)
  v_mfma_f32_16x16x32_bf16 v[20:23], v[120:123], v[88:91], v[20:23]
  s_add_u32 s44, s52, s33
  buffer_load_dwordx4 a[104:107], v80, s[8:11], s44 offen
  ds_write_b128 v143, a[72:75] offset:3072
  s_waitcnt vmcnt(14)
  v_mfma_f32_16x16x32_bf16 v[40:43], v[120:123], v[128:131], v[40:43]
  ds_write_b128 v143, a[76:79] offset:4096
  s_waitcnt vmcnt(13)
  v_mfma_f32_16x16x32_bf16 v[60:63], v[120:123], v[92:95], v[60:63]
  s_waitcnt vmcnt(12)
  v_mfma_f32_16x16x32_bf16 v[4:7], v[96:99], v[84:87], v[4:7]
  s_waitcnt lgkmcnt(0)
  v_mov_b32 v82, 31744
  v_mov_b32 v83, 1
  ds_add_u32 v82, v83 offset:8
  s_add_u32 s44, s40, 55296
  buffer_load_dwordx4 a[0:3], v80, s[8:11], s44 offen
  v_mfma_f32_16x16x32_bf16 v[24:27], v[96:99], v[88:91], v[24:27]
  s_add_u32 s44, s48, 55296
  buffer_load_dwordx4 a[16:19], v80, s[8:11], s44 offen
  v_mfma_f32_16x16x32_bf16 v[44:47], v[96:99], v[128:131], v[44:47]
  s_add_u32 s44, s41, 55296
  buffer_load_dwordx4 a[4:7], v80, s[8:11], s44 offen
  v_mfma_f32_16x16x32_bf16 v[64:67], v[96:99], v[92:95], v[64:67]
  s_waitcnt vmcnt(14)
  v_mfma_f32_16x16x32_bf16 v[8:11], v[112:115], v[84:87], v[8:11]
  s_add_u32 s44, s42, 55296
  buffer_load_dwordx4 a[8:11], v80, s[8:11], s44 offen
  v_mfma_f32_16x16x32_bf16 v[28:31], v[112:115], v[88:91], v[28:31]
  s_add_u32 s44, s43, 55296
  buffer_load_dwordx4 a[12:15], v80, s[8:11], s44 offen
  v_mfma_f32_16x16x32_bf16 v[48:51], v[112:115], v[128:131], v[48:51]
  v_mfma_f32_16x16x32_bf16 v[68:71], v[112:115], v[92:95], v[68:71]
  s_waitcnt vmcnt(15)
  v_mfma_f32_16x16x32_bf16 v[12:15], v[116:119], v[84:87], v[12:15]
  s_add_u32 s44, s49, 55296
  buffer_load_dwordx4 a[20:23], v80, s[8:11], s44 offen
  v_mfma_f32_16x16x32_bf16 v[32:35], v[116:119], v[88:91], v[32:35]
  s_add_u32 s44, s50, 55296
  buffer_load_dwordx4 a[24:27], v80, s[8:11], s44 offen
  v_mfma_f32_16x16x32_bf16 v[52:55], v[116:119], v[128:131], v[52:55]
  v_mfma_f32_16x16x32_bf16 v[72:75], v[116:119], v[92:95], v[72:75]
  s_waitcnt vmcnt(16)
  v_mfma_f32_16x16x32_bf16 v[16:19], v[108:111], v[84:87], v[16:19]
  s_add_u32 s44, s51, 55296
  buffer_load_dwordx4 a[28:31], v80, s[8:11], s44 offen
  v_mfma_f32_16x16x32_bf16 v[36:39], v[108:111], v[88:91], v[36:39]
  s_add_u32 s44, s52, 55296
  buffer_load_dwordx4 a[32:35], v80, s[8:11], s44 offen
  v_mfma_f32_16x16x32_bf16 v[56:59], v[108:111], v[128:131], v[56:59]
  v_mfma_f32_16x16x32_bf16 v[76:79], v[108:111], v[92:95], v[76:79]
  s_mov_b32 s37, 0
  s_waitcnt vmcnt(16)
  v_mfma_f32_16x16x32_bf16 v[0:3], v[132:135], v[136:139], v[0:3]
  s_waitcnt vmcnt(15)
  v_mfma_f32_16x16x32_bf16 v[20:23], v[132:135], a[80:83], v[20:23]
  s_waitcnt vmcnt(14)
  v_mfma_f32_16x16x32_bf16 v[40:43], v[132:135], a[84:87], v[40:43]
  s_waitcnt vmcnt(13)
  v_mfma_f32_16x16x32_bf16 v[60:63], v[132:135], a[88:91], v[60:63]
  s_waitcnt vmcnt(12)
  v_mfma_f32_16x16x32_bf16 v[4:7], a[92:95], v[136:139], v[4:7]
  s_waitcnt lgkmcnt(0)
  s_mov_b32 s37, 0
L_k2_kernel_ms:
  ds_read_b32 v83, v82 offset:8
  s_waitcnt lgkmcnt(0)
  v_readfirstlane_b32 s23, v83
  s_add_u32 s37, s37, 1
  s_cmp_ge_u32 s23, 256
  s_cbranch_scc1 L_k2_kernel_ms_ok
  s_cmp_lt_u32 s37, 1000000
  s_cbranch_scc1 L_k2_kernel_ms
L_k2_kernel_ms_ok:
  ds_read_b128 v[84:87], v144 offset:0
  ds_read_b128 v[88:91], v144 offset:5120
  ds_read_b128 v[92:95], v144 offset:10240
  ds_read_b128 v[96:99], v144 offset:15360
  ds_read_b128 v[100:103], v144 offset:1024
  ds_read_b128 v[104:107], v144 offset:6144
  ds_read_b128 v[108:111], v144 offset:11264
  ds_read_b128 v[112:115], v144 offset:16384
  v_mfma_f32_16x16x32_bf16 v[24:27], a[92:95], a[80:83], v[24:27]
  s_waitcnt lgkmcnt(6)
  v_add_f32 v84, v84, v88
  v_add_f32 v85, v85, v89
  v_add_f32 v86, v86, v90
  s_add_u32 s44, s40, 59392
  buffer_load_dwordx4 a[36:39], v80, s[8:11], s44 offen
  v_add_f32 v87, v87, v91
  s_waitcnt lgkmcnt(4)
  v_add_f32 v92, v92, v96
  v_add_f32 v93, v93, v97
  v_add_f32 v94, v94, v98
  v_add_f32 v95, v95, v99
  v_mfma_f32_16x16x32_bf16 v[44:47], a[92:95], a[84:87], v[44:47]
  v_add_f32 v84, v84, v92
  v_add_f32 v85, v85, v93
  v_add_f32 v86, v86, v94
  v_add_f32 v87, v87, v95
  v_cvt_pk_bf16_f32 v116, v84, v85
  s_add_u32 s44, s48, 59392
  buffer_load_dwordx4 a[52:55], v80, s[8:11], s44 offen
  v_cvt_pk_bf16_f32 v117, v86, v87
  ds_read_b128 v[84:87], v144 offset:2048
  ds_read_b128 v[88:91], v144 offset:7168
  v_mfma_f32_16x16x32_bf16 v[64:67], a[92:95], a[88:91], v[64:67]
  s_waitcnt vmcnt(13)
  v_mfma_f32_16x16x32_bf16 v[8:11], a[96:99], v[136:139], v[8:11]
  ds_read_b128 v[92:95], v144 offset:12288
  ds_read_b128 v[96:99], v144 offset:17408
  s_waitcnt lgkmcnt(6)
  v_add_f32 v100, v100, v104
  v_add_f32 v101, v101, v105
  v_add_f32 v102, v102, v106
  v_add_f32 v103, v103, v107
  s_waitcnt lgkmcnt(4)
  v_add_f32 v108, v108, v112
  v_add_f32 v109, v109, v113
  s_add_u32 s44, s41, 59392
  buffer_load_dwordx4 a[40:43], v80, s[8:11], s44 offen
  v_mfma_f32_16x16x32_bf16 v[28:31], a[96:99], a[80:83], v[28:31]
  v_add_f32 v110, v110, v114
  v_add_f32 v111, v111, v115
  v_add_f32 v100, v100, v108
  v_add_f32 v101, v101, v109
  v_add_f32 v102, v102, v110
  v_add_f32 v103, v103, v111
  v_cvt_pk_bf16_f32 v118, v100, v101
  v_cvt_pk_bf16_f32 v119, v102, v103
  buffer_store_dwordx4 v[116:119], v80, s[8:11], s45 offen offset:0 sc1
  v_mfma_f32_16x16x32_bf16 v[48:51], a[96:99], a[84:87], v[48:51]
  ds_read_b128 v[100:103], v144 offset:3072
  s_add_u32 s44, s42, 59392
  buffer_load_dwordx4 a[44:47], v80, s[8:11], s44 offen
  ds_read_b128 v[104:107], v144 offset:8192
  ds_read_b128 v[108:111], v144 offset:13312
  ds_read_b128 v[112:115], v144 offset:18432
  s_waitcnt lgkmcnt(6)
  v_add_f32 v84, v84, v88
  v_add_f32 v85, v85, v89
  v_add_f32 v86, v86, v90
  v_mfma_f32_16x16x32_bf16 v[68:71], a[96:99], a[88:91], v[68:71]
  s_waitcnt vmcnt(15)
  v_mfma_f32_16x16x32_bf16 v[12:15], a[100:103], v[136:139], v[12:15]
  v_add_f32 v87, v87, v91
  s_waitcnt lgkmcnt(4)
  v_add_f32 v92, v92, v96
  v_add_f32 v93, v93, v97
  v_add_f32 v94, v94, v98
  v_add_f32 v95, v95, v99
  s_add_u32 s44, s43, 59392
  buffer_load_dwordx4 a[48:51], v80, s[8:11], s44 offen
  v_add_f32 v84, v84, v92
  v_add_f32 v85, v85, v93
  v_add_f32 v86, v86, v94
  v_mfma_f32_16x16x32_bf16 v[32:35], a[100:103], a[80:83], v[32:35]
  v_add_f32 v87, v87, v95
  v_cvt_pk_bf16_f32 v120, v84, v85
  v_cvt_pk_bf16_f32 v121, v86, v87
  ds_read_b128 v[84:87], v144 offset:4096
  ds_read_b128 v[88:91], v144 offset:9216
  ds_read_b128 v[92:95], v144 offset:14336
  ds_read_b128 v[96:99], v144 offset:19456
  s_add_u32 s44, s49, 59392
  buffer_load_dwordx4 a[56:59], v80, s[8:11], s44 offen
  s_waitcnt lgkmcnt(6)
  v_add_f32 v100, v100, v104
  v_mfma_f32_16x16x32_bf16 v[52:55], a[100:103], a[84:87], v[52:55]
  v_add_f32 v101, v101, v105
  v_add_f32 v102, v102, v106
  v_add_f32 v103, v103, v107
  s_waitcnt lgkmcnt(4)
  v_add_f32 v108, v108, v112
  v_add_f32 v109, v109, v113
  v_add_f32 v110, v110, v114
  v_add_f32 v111, v111, v115
  v_add_f32 v100, v100, v108
  v_mfma_f32_16x16x32_bf16 v[72:75], a[100:103], a[88:91], v[72:75]
  s_waitcnt vmcnt(16)
  v_mfma_f32_16x16x32_bf16 v[16:19], a[104:107], v[136:139], v[16:19]
  v_add_f32 v101, v101, v109
  v_add_f32 v102, v102, v110
  s_add_u32 s44, s50, 59392
  buffer_load_dwordx4 a[60:63], v80, s[8:11], s44 offen
  v_add_f32 v103, v103, v111
  v_cvt_pk_bf16_f32 v122, v100, v101
  v_cvt_pk_bf16_f32 v123, v102, v103
  buffer_store_dwordx4 v[120:123], v80, s[8:11], s45 offen offset:1024 sc1
  s_waitcnt lgkmcnt(2)
  v_add_f32 v84, v84, v88
  v_add_f32 v85, v85, v89
  v_mfma_f32_16x16x32_bf16 v[36:39], a[104:107], a[80:83], v[36:39]
  v_add_f32 v86, v86, v90
  v_add_f32 v87, v87, v91
  s_waitcnt lgkmcnt(0)
  v_add_f32 v92, v92, v96
  v_add_f32 v93, v93, v97
  s_add_u32 s44, s51, 59392
  buffer_load_dwordx4 a[64:67], v80, s[8:11], s44 offen
  v_add_f32 v94, v94, v98
  v_add_f32 v95, v95, v99
  v_add_f32 v84, v84, v92
  v_mfma_f32_16x16x32_bf16 v[56:59], a[104:107], a[84:87], v[56:59]
  v_add_f32 v85, v85, v93
  v_add_f32 v86, v86, v94
  v_add_f32 v87, v87, v95
  v_cvt_pk_bf16_f32 v124, v84, v85
  v_cvt_pk_bf16_f32 v125, v86, v87
  v_lshlrev_b32 v127, 3, v81
  buffer_store_dwordx2 v[124:125], v127, s[8:11], s45 offen offset:2048 sc1
  s_add_u32 s44, s52, 59392
  buffer_load_dwordx4 a[68:71], v80, s[8:11], s44 offen
  v_mfma_f32_16x16x32_bf16 v[76:79], a[104:107], a[88:91], v[76:79]
  s_waitcnt vmcnt(20)
  v_accvgpr_read_b32 v92, a0
  s_waitcnt vmcnt(18)
  v_accvgpr_read_b32 v93, a4
  s_waitcnt vmcnt(17)
  v_accvgpr_read_b32 v129, a8
  s_waitcnt vmcnt(16)
  v_accvgpr_read_b32 v82, a12
  v_max3_u32 v92, v92, v93, v129
  v_max_u32 v92, v92, v82
  v_cmp_eq_u32 vcc, -1, v92
  s_nop 0
  s_cbranch_vccnz L_k2_kernel_tg14_no
L_k2_kernel_tg14_ok:
  v_mfma_f32_16x16x32_bf16 v[0:3], a[16:19], a[0:3], v[0:3]
  s_add_u32 s44, s40, 63488
  buffer_load_dwordx4 a[72:75], v80, s[8:11], s44 offen
  s_add_u32 s44, s48, 63488
  buffer_load_dwordx4 a[88:91], v80, s[8:11], s44 offen
  v_and_b32 v138, 15, v81
  v_mfma_f32_16x16x32_bf16 v[20:23], a[16:19], a[4:7], v[20:23]
  v_lshrrev_b32 v139, 4, v81
  v_lshlrev_b32 v136, 7, v139
  v_mfma_f32_16x16x32_bf16 v[40:43], a[16:19], a[8:11], v[40:43]
  v_lshl_add_u32 v126, v138, 3, v136
  s_lshl_b32 s23, s27, 6
  v_mfma_f32_16x16x32_bf16 v[60:63], a[16:19], a[12:15], v[60:63]
  s_waitcnt vmcnt(17)
  v_mfma_f32_16x16x32_bf16 v[4:7], a[20:23], a[0:3], v[4:7]
  s_add_u32 s44, s41, 63488
  buffer_load_dwordx4 a[76:79], v80, s[8:11], s44 offen
  s_add_u32 s44, s42, 63488
  buffer_load_dwordx4 a[80:83], v80, s[8:11], s44 offen
  s_lshl_b32 s24, s22, 4
  v_mfma_f32_16x16x32_bf16 v[24:27], a[20:23], a[4:7], v[24:27]
  s_add_u32 s23, s23, s24
  s_mul_i32 s23, s23, 1280
  v_mfma_f32_16x16x32_bf16 v[44:47], a[20:23], a[8:11], v[44:47]
  s_mul_i32 s24, s28, 160
  s_add_u32 s23, s23, s24
  v_mfma_f32_16x16x32_bf16 v[64:67], a[20:23], a[12:15], v[64:67]
  s_waitcnt vmcnt(18)
  v_mfma_f32_16x16x32_bf16 v[8:11], a[24:27], a[0:3], v[8:11]
  s_add_u32 s44, s43, 63488
  buffer_load_dwordx4 a[84:87], v80, s[8:11], s44 offen
  s_add_u32 s44, s49, 63488
  buffer_load_dwordx4 a[92:95], v80, s[8:11], s44 offen
  s_lshl_b32 s24, s38, 5
  v_mfma_f32_16x16x32_bf16 v[28:31], a[24:27], a[4:7], v[28:31]
  s_add_u32 s24, s24, s23
  v_lshrrev_b32 v136, 2, v81
  v_mfma_f32_16x16x32_bf16 v[48:51], a[24:27], a[8:11], v[48:51]
  v_mul_u32_u24 v136, 1280, v136
  v_bfe_u32 v137, v81, 3, 2
  v_mfma_f32_16x16x32_bf16 v[68:71], a[24:27], a[12:15], v[68:71]
  s_waitcnt vmcnt(19)
  v_mfma_f32_16x16x32_bf16 v[12:15], a[28:31], a[0:3], v[12:15]
  s_add_u32 s44, s50, 63488
  buffer_load_dwordx4 a[96:99], v80, s[8:11], s44 offen
  s_add_u32 s44, s51, 63488
  buffer_load_dwordx4 a[100:103], v80, s[8:11], s44 offen
  v_xor_b32 v137, v137, v81
  v_mfma_f32_16x16x32_bf16 v[32:35], a[28:31], a[4:7], v[32:35]
  v_lshrrev_b32 v138, 5, v81
  v_xor_b32 v137, v137, v138
  v_mfma_f32_16x16x32_bf16 v[52:55], a[28:31], a[8:11], v[52:55]
  v_and_b32 v137, 3, v137
  v_lshl_add_u32 v94, v137, 4, v136
  v_mfma_f32_16x16x32_bf16 v[72:75], a[28:31], a[12:15], v[72:75]
  s_waitcnt vmcnt(20)
  v_mfma_f32_16x16x32_bf16 v[16:19], a[32:35], a[0:3], v[16:19]
  s_waitcnt vmcnt(19)
  v_accvgpr_read_b32 v92, a36
  s_waitcnt vmcnt(17)
  v_accvgpr_read_b32 v93, a40
  s_waitcnt vmcnt(15)
  v_accvgpr_read_b32 v129, a44
  s_waitcnt vmcnt(14)
  v_accvgpr_read_b32 v82, a48
  v_max3_u32 v92, v92, v93, v129
  v_mfma_f32_16x16x32_bf16 v[36:39], a[32:35], a[4:7], v[36:39]
  v_max_u32 v92, v92, v82
  v_cmp_eq_u32 vcc, -1, v92
  s_nop 0
  s_cbranch_vccnz L_k2_kernel_tg15_no
L_k2_kernel_tg15_ok:
  s_add_u32 s44, s52, 63488
  buffer_load_dwordx4 a[104:107], v80, s[8:11], s44 offen
  v_add_u32 v94, s24, v94
  v_mfma_f32_16x16x32_bf16 v[56:59], a[32:35], a[8:11], v[56:59]
  s_cmp_eq_u32 s38, 1
  s_cselect_b32 s24, 0, 128
  s_add_u32 s24, s24, s23
  v_lshl_add_u32 v95, v137, 3, v136
  v_add_u32 v95, s24, v95
  v_mfma_f32_16x16x32_bf16 v[76:79], a[32:35], a[12:15], v[76:79]
  v_mfma_f32_16x16x32_bf16 v[0:3], a[52:55], a[36:39], v[0:3]
  s_waitcnt vmcnt(10)
  v_mov_b32 v83, 1
  buffer_store_dword v83, v147, s[8:11], s68 offen sc1
  s_add_u32 s44, s40, 67584
  buffer_load_dwordx4 a[0:3], v80, s[8:11], s44 offen
  s_add_u32 s44, s41, 67584
  buffer_load_dwordx4 a[4:7], v80, s[8:11], s44 offen
  v_and_b32 v138, 15, v81
  v_lshrrev_b32 v139, 4, v81
  v_mfma_f32_16x16x32_bf16 v[20:23], a[52:55], a[40:43], v[20:23]
  v_bfe_u32 v136, v138, 1, 2
  v_xor_b32 v136, v136, v139
  v_lshrrev_b32 v137, 3, v138
  v_xor_b32 v136, v136, v137
  v_mfma_f32_16x16x32_bf16 v[40:43], a[52:55], a[44:47], v[40:43]
  v_lshl_add_u32 v136, v138, 2, v136
  v_lshlrev_b32 v136, 3, v136
  s_add_u32 s23, s22, 0
  s_and_b32 s23, s23, 3
  v_mfma_f32_16x16x32_bf16 v[60:63], a[52:55], a[48:51], v[60:63]
  v_mfma_f32_16x16x32_bf16 v[4:7], a[56:59], a[36:39], v[4:7]
  s_add_u32 s44, s42, 67584
  buffer_load_dwordx4 a[8:11], v80, s[8:11], s44 offen
  s_add_u32 s44, s43, 67584
  buffer_load_dwordx4 a[12:15], v80, s[8:11], s44 offen
  s_mul_i32 s23, s23, 10240
  s_add_u32 s23, s23, 32768
  v_mfma_f32_16x16x32_bf16 v[24:27], a[56:59], a[40:43], v[24:27]
  v_add_u32 v140, s23, v136
  s_add_u32 s23, s22, 1
  s_and_b32 s23, s23, 3
  s_mul_i32 s23, s23, 10240
  v_mfma_f32_16x16x32_bf16 v[44:47], a[56:59], a[44:47], v[44:47]
  s_add_u32 s23, s23, 35328
  v_add_u32 v141, s23, v136
  s_add_u32 s23, s22, 2
  s_and_b32 s23, s23, 3
  v_mfma_f32_16x16x32_bf16 v[64:67], a[56:59], a[48:51], v[64:67]
  v_mfma_f32_16x16x32_bf16 v[8:11], a[60:63], a[36:39], v[8:11]
  s_add_u32 s44, s40, 71680
  buffer_load_dwordx2 v[96:97], v126, s[8:11], s44 offen
  buffer_load_dwordx2 v[98:99], v126, s[8:11], s44 offen offset:512
  s_add_u32 s44, s41, 71680
  buffer_load_dwordx2 v[100:101], v126, s[8:11], s44 offen
  buffer_load_dwordx2 v[102:103], v126, s[8:11], s44 offen offset:512
  s_mul_i32 s23, s23, 10240
  s_add_u32 s23, s23, 37888
  v_mfma_f32_16x16x32_bf16 v[28:31], a[60:63], a[40:43], v[28:31]
  v_add_u32 v142, s23, v136
  s_add_u32 s23, s22, 3
  s_and_b32 s23, s23, 3
  s_mul_i32 s23, s23, 10240
  v_mfma_f32_16x16x32_bf16 v[48:51], a[60:63], a[44:47], v[48:51]
  s_add_u32 s23, s23, 40448
  v_add_u32 v143, s23, v136
  s_mul_i32 s23, s22, 10240
  v_mfma_f32_16x16x32_bf16 v[68:71], a[60:63], a[48:51], v[68:71]
  v_mfma_f32_16x16x32_bf16 v[12:15], a[64:67], a[36:39], v[12:15]
  s_add_u32 s44, s42, 71680
  buffer_load_dwordx2 v[104:105], v126, s[8:11], s44 offen
  buffer_load_dwordx2 v[106:107], v126, s[8:11], s44 offen offset:512
  s_add_u32 s44, s43, 71680
  buffer_load_dwordx2 v[108:109], v126, s[8:11], s44 offen
  buffer_load_dwordx2 v[110:111], v126, s[8:11], s44 offen offset:512
  s_add_u32 s23, s23, 32768
  v_lshlrev_b32 v136, 3, v81
  v_add_u32 v144, s23, v136
  v_mfma_f32_16x16x32_bf16 v[32:35], a[64:67], a[40:43], v[32:35]
  v_lshrrev_b32 v136, 2, v138
  v_and_b32 v137, 1, v138
  v_lshlrev_b32 v137, 4, v137
  v_mov_b32 v130, 0x3f80
  v_lshlrev_b32 v130, v137, v130
  v_mfma_f32_16x16x32_bf16 v[52:55], a[64:67], a[44:47], v[52:55]
  v_mov_b32 v131, 0
  v_cmp_eq_u32 vcc, v136, v139
  s_nop 1
  v_cndmask_b32 v130, v131, v130, vcc
  buffer_load_dwordx4 v[84:87], v94, s[4:7], 0 offen
  buffer_load_dwordx4 v[88:91], v94, s[4:7], 0 offen offset:64
  buffer_load_dwordx2 v[112:113], v95, s[4:7], 0 offen
  v_mfma_f32_16x16x32_bf16 v[72:75], a[64:67], a[48:51], v[72:75]
  s_waitcnt vmcnt(25)
  v_mfma_f32_16x16x32_bf16 v[16:19], a[68:71], a[36:39], v[16:19]
  s_waitcnt vmcnt(24)
  v_accvgpr_read_b32 v92, a72
  s_waitcnt vmcnt(22)
  v_accvgpr_read_b32 v93, a76
  s_waitcnt vmcnt(21)
  v_accvgpr_read_b32 v129, a80
  s_waitcnt vmcnt(20)
  v_accvgpr_read_b32 v82, a84
  v_max3_u32 v92, v92, v93, v129
  v_max_u32 v92, v92, v82
  v_mfma_f32_16x16x32_bf16 v[36:39], a[68:71], a[40:43], v[36:39]
  v_cmp_eq_u32 vcc, -1, v92
  s_nop 0
  s_cbranch_vccnz L_k2_kernel_tg16_no
L_k2_kernel_tg16_ok:
  s_add_u32 s44, s48, 67584
  buffer_load_dwordx4 a[16:19], v80, s[8:11], s44 offen
  v_and_b32 v136, 2, v138
  v_cmp_eq_u32 vcc, 0, v136
  s_nop 1
  v_cndmask_b32 v132, v131, v130, vcc
  v_cndmask_b32 v133, v130, v131, vcc
  v_mov_b32 v130, 0
  v_mov_b32 v134, 0
  v_mfma_f32_16x16x32_bf16 v[56:59], a[68:71], a[44:47], v[56:59]
  v_mov_b32 v135, 0
  v_mov_b32 v136, v132
  v_mov_b32 v137, v133
  v_mov_b32 v138, v132
  v_mov_b32 v139, v133
  v_mfma_f32_16x16x32_bf16 v[76:79], a[68:71], a[48:51], v[76:79]
  s_barrier
  v_mfma_f32_16x16x32_bf16 v[0:3], a[88:91], a[72:75], v[0:3]
  buffer_load_dword v128, v147, s[8:11], s69 offen sc1
  v_mfma_f32_16x16x32_bf16 v[20:23], a[88:91], a[76:79], v[20:23]
  s_add_u32 s44, s48, 71680
  buffer_load_dwordx4 a[52:55], v80, s[8:11], s44 offen
  v_mfma_f32_16x16x32_bf16 v[40:43], a[88:91], a[80:83], v[40:43]
  s_add_u32 s44, s49, 67584
  buffer_load_dwordx4 a[20:23], v80, s[8:11], s44 offen
  v_mfma_f32_16x16x32_bf16 v[60:63], a[88:91], a[84:87], v[60:63]
  s_waitcnt vmcnt(23)
  v_mfma_f32_16x16x32_bf16 v[4:7], a[92:95], a[72:75], v[4:7]
  s_add_u32 s44, s49, 71680
  buffer_load_dwordx4 a[56:59], v80, s[8:11], s44 offen
  v_mfma_f32_16x16x32_bf16 v[24:27], a[92:95], a[76:79], v[24:27]
  s_add_u32 s44, s50, 67584
  buffer_load_dwordx4 a[24:27], v80, s[8:11], s44 offen
  v_mfma_f32_16x16x32_bf16 v[44:47], a[92:95], a[80:83], v[44:47]
  v_mfma_f32_16x16x32_bf16 v[64:67], a[92:95], a[84:87], v[64:67]
  s_waitcnt vmcnt(24)
  v_mfma_f32_16x16x32_bf16 v[8:11], a[96:99], a[72:75], v[8:11]
  s_add_u32 s44, s50, 71680
  buffer_load_dwordx4 a[60:63], v80, s[8:11], s44 offen
  v_mfma_f32_16x16x32_bf16 v[28:31], a[96:99], a[76:79], v[28:31]
  s_add_u32 s44, s51, 67584
  buffer_load_dwordx4 a[28:31], v80, s[8:11], s44 offen
  v_mfma_f32_16x16x32_bf16 v[48:51], a[96:99], a[80:83], v[48:51]
  v_mfma_f32_16x16x32_bf16 v[68:71], a[96:99], a[84:87], v[68:71]
  s_waitcnt vmcnt(25)
  v_mfma_f32_16x16x32_bf16 v[12:15], a[100:103], a[72:75], v[12:15]
  s_add_u32 s44, s51, 71680
  buffer_load_dwordx4 a[64:67], v80, s[8:11], s44 offen
  v_mfma_f32_16x16x32_bf16 v[32:35], a[100:103], a[76:79], v[32:35]
  s_add_u32 s44, s52, 67584
  buffer_load_dwordx4 a[32:35], v80, s[8:11], s44 offen
  v_mfma_f32_16x16x32_bf16 v[52:55], a[100:103], a[80:83], v[52:55]
  v_mfma_f32_16x16x32_bf16 v[72:75], a[100:103], a[84:87], v[72:75]
  s_waitcnt vmcnt(26)
  v_mfma_f32_16x16x32_bf16 v[16:19], a[104:107], a[72:75], v[16:19]
  s_add_u32 s44, s52, 71680
  buffer_load_dwordx4 a[68:71], v80, s[8:11], s44 offen
  v_mfma_f32_16x16x32_bf16 v[36:39], a[104:107], a[76:79], v[36:39]
  v_mfma_f32_16x16x32_bf16 v[56:59], a[104:107], a[80:83], v[56:59]
  v_mfma_f32_16x16x32_bf16 v[76:79], a[104:107], a[84:87], v[76:79]
  s_waitcnt vmcnt(25)
  v_accvgpr_read_b32 v92, a0
  s_waitcnt vmcnt(24)
  v_accvgpr_read_b32 v93, a4
  s_waitcnt vmcnt(23)
  v_accvgpr_read_b32 v129, a8
  s_waitcnt vmcnt(22)
  v_accvgpr_read_b32 v82, a12
  v_max3_u32 v92, v92, v93, v129
  v_max_u32 v92, v92, v82
  v_cmp_eq_u32 vcc, -1, v92
  s_nop 0
  s_cbranch_vccnz L_k2_kernel_tg17_no
L_k2_kernel_tg17_ok:
  s_waitcnt vmcnt(19)
  v_max3_u32 v92, v96, v98, v100
  s_waitcnt vmcnt(16)
  v_max3_u32 v93, v102, v104, v106
  s_waitcnt vmcnt(14)
  v_max3_u32 v92, v92, v108, v110
  v_max_u32 v92, v92, v93
  v_cmp_eq_u32 vcc, -1, v92
  s_nop 0
  s_cbranch_vccnz L_k2_kernel_tg18_no
L_k2_kernel_tg18_ok:
  s_mov_b32 s37, 0
L_k2_kernel_xp:
  s_waitcnt vmcnt(9)
  v_readfirstlane_b32 s23, v128
  s_nop 0
  s_cmp_lg_u32 s23, 0
  s_cbranch_scc1 L_k2_kernel_xp_ok
  s_add_u32 s37, s37, 1
  s_cmp_gt_u32 s37, 200000
  s_cbranch_scc1 L_k2_kernel_xp_ok
  buffer_load_dword v128, v147, s[8:11], s69 offen sc1
  s_waitcnt vmcnt(0)
  s_branch L_k2_kernel_xp
L_k2_kernel_xp_ok:
  buffer_load_dwordx4 v[116:119], v80, s[8:11], s47 offen sc1
  buffer_load_dwordx4 v[120:123], v80, s[8:11], s47 offen offset:1024 sc1
  buffer_load_dwordx2 v[114:115], v127, s[8:11], s47 offen offset:2048 sc1
  v_mfma_f32_16x16x32_bf16 v[20:23], a[16:19], a[4:7], v[20:23]
  v_mfma_f32_16x16x32_bf16 v[40:43], a[16:19], a[8:11], v[40:43]
  v_mfma_f32_16x16x32_bf16 v[60:63], a[16:19], a[12:15], v[60:63]
  v_mfma_f32_16x16x32_bf16 v[0:3], a[16:19], a[0:3], v[0:3]
  s_waitcnt vmcnt(11)
  v_mfma_f32_16x16x32_bf16 v[20:23], a[52:55], v[100:103], v[20:23]
  v_mfma_f32_16x16x32_bf16 v[40:43], a[52:55], v[104:107], v[40:43]
  v_mfma_f32_16x16x32_bf16 v[60:63], a[52:55], v[108:111], v[60:63]
  v_mfma_f32_16x16x32_bf16 v[0:3], a[52:55], v[96:99], v[0:3]
  s_waitcnt vmcnt(10)
  v_mfma_f32_16x16x32_bf16 v[24:27], a[20:23], a[4:7], v[24:27]
  s_nop 2
  v_cvt_pk_bf16_f32 v20, v20, v21
  v_cvt_pk_bf16_f32 v21, v22, v23
  v_mfma_f32_16x16x32_bf16 v[44:47], a[20:23], a[8:11], v[44:47]
  ds_write_b64 v141, v[20:21] offset:0
  v_cvt_pk_bf16_f32 v40, v40, v41
  v_mfma_f32_16x16x32_bf16 v[64:67], a[20:23], a[12:15], v[64:67]
  v_cvt_pk_bf16_f32 v41, v42, v43
  ds_write_b64 v142, v[40:41] offset:0
  v_mfma_f32_16x16x32_bf16 v[4:7], a[20:23], a[0:3], v[4:7]
  v_cvt_pk_bf16_f32 v60, v60, v61
  s_waitcnt vmcnt(9)
  v_mfma_f32_16x16x32_bf16 v[24:27], a[56:59], v[100:103], v[24:27]
  v_cvt_pk_bf16_f32 v61, v62, v63
  ds_write_b64 v143, v[60:61] offset:0
  v_mfma_f32_16x16x32_bf16 v[44:47], a[56:59], v[104:107], v[44:47]
  v_cvt_pk_bf16_f32 v0, v0, v1
  v_cvt_pk_bf16_f32 v1, v2, v3
  v_mfma_f32_16x16x32_bf16 v[64:67], a[56:59], v[108:111], v[64:67]
  ds_write_b64 v140, v[0:1] offset:0
  v_mfma_f32_16x16x32_bf16 v[4:7], a[56:59], v[96:99], v[4:7]
  s_waitcnt vmcnt(8)
  v_mfma_f32_16x16x32_bf16 v[28:31], a[24:27], a[4:7], v[28:31]
  v_cvt_pk_bf16_f32 v24, v24, v25
  v_cvt_pk_bf16_f32 v25, v26, v27
  v_mfma_f32_16x16x32_bf16 v[48:51], a[24:27], a[8:11], v[48:51]
  ds_write_b64 v141, v[24:25] offset:512
  v_cvt_pk_bf16_f32 v44, v44, v45
  v_mfma_f32_16x16x32_bf16 v[68:71], a[24:27], a[12:15], v[68:71]
  v_cvt_pk_bf16_f32 v45, v46, v47
  ds_write_b64 v142, v[44:45] offset:512
  v_mfma_f32_16x16x32_bf16 v[8:11], a[24:27], a[0:3], v[8:11]
  v_cvt_pk_bf16_f32 v64, v64, v65
  s_waitcnt vmcnt(7)
  v_mfma_f32_16x16x32_bf16 v[28:31], a[60:63], v[100:103], v[28:31]
  v_cvt_pk_bf16_f32 v65, v66, v67
  ds_write_b64 v143, v[64:65] offset:512
  v_mfma_f32_16x16x32_bf16 v[48:51], a[60:63], v[104:107], v[48:51]
  v_cvt_pk_bf16_f32 v4, v4, v5
  v_cvt_pk_bf16_f32 v5, v6, v7
  v_mfma_f32_16x16x32_bf16 v[68:71], a[60:63], v[108:111], v[68:71]
  ds_write_b64 v140, v[4:5] offset:512
  v_mfma_f32_16x16x32_bf16 v[8:11], a[60:63], v[96:99], v[8:11]
  s_waitcnt vmcnt(6)
  v_mfma_f32_16x16x32_bf16 v[32:35], a[28:31], a[4:7], v[32:35]
  v_cvt_pk_bf16_f32 v28, v28, v29
  v_cvt_pk_bf16_f32 v29, v30, v31
  v_mfma_f32_16x16x32_bf16 v[52:55], a[28:31], a[8:11], v[52:55]
  ds_write_b64 v141, v[28:29] offset:1024
  v_cvt_pk_bf16_f32 v48, v48, v49
  v_mfma_f32_16x16x32_bf16 v[72:75], a[28:31], a[12:15], v[72:75]
  v_cvt_pk_bf16_f32 v49, v50, v51
  ds_write_b64 v142, v[48:49] offset:1024
  v_mfma_f32_16x16x32_bf16 v[12:15], a[28:31], a[0:3], v[12:15]
  v_cvt_pk_bf16_f32 v68, v68, v69
  s_waitcnt vmcnt(5)
  v_mfma_f32_16x16x32_bf16 v[32:35], a[64:67], v[100:103], v[32:35]
  v_cvt_pk_bf16_f32 v69, v70, v71
  ds_write_b64 v143, v[68:69] offset:1024
  v_mfma_f32_16x16x32_bf16 v[52:55], a[64:67], v[104:107], v[52:55]
  v_cvt_pk_bf16_f32 v8, v8, v9
  v_cvt_pk_bf16_f32 v9, v10, v11
  v_mfma_f32_16x16x32_bf16 v[72:75], a[64:67], v[108:111], v[72:75]
  ds_write_b64 v140, v[8:9] offset:1024
  v_mfma_f32_16x16x32_bf16 v[12:15], a[64:67], v[96:99], v[12:15]
  s_waitcnt vmcnt(4)
  v_mfma_f32_16x16x32_bf16 v[36:39], a[32:35], a[4:7], v[36:39]
  v_cvt_pk_bf16_f32 v32, v32, v33
  v_cvt_pk_bf16_f32 v33, v34, v35
  v_mfma_f32_16x16x32_bf16 v[56:59], a[32:35], a[8:11], v[56:59]
  ds_write_b64 v141, v[32:33] offset:1536
  v_cvt_pk_bf16_f32 v52, v52, v53
  v_mfma_f32_16x16x32_bf16 v[76:79], a[32:35], a[12:15], v[76:79]
  v_cvt_pk_bf16_f32 v53, v54, v55
  ds_write_b64 v142, v[52:53] offset:1536
  v_mfma_f32_16x16x32_bf16 v[16:19], a[32:35], a[0:3], v[16:19]
  v_cvt_pk_bf16_f32 v72, v72, v73
  s_waitcnt vmcnt(3)
  v_mfma_f32_16x16x32_bf16 v[36:39], a[68:71], v[100:103], v[36:39]
  v_cvt_pk_bf16_f32 v73, v74, v75
  ds_write_b64 v143, v[72:73] offset:1536
  v_mfma_f32_16x16x32_bf16 v[56:59], a[68:71], v[104:107], v[56:59]
  v_cvt_pk_bf16_f32 v12, v12, v13
  v_cvt_pk_bf16_f32 v13, v14, v15
  v_mfma_f32_16x16x32_bf16 v[76:79], a[68:71], v[108:111], v[76:79]
  ds_write_b64 v140, v[12:13] offset:1536
  v_mfma_f32_16x16x32_bf16 v[16:19], a[68:71], v[96:99], v[16:19]
  v_cvt_pk_bf16_f32 v36, v36, v37
  v_cvt_pk_bf16_f32 v37, v38, v39
  v_mfma_f32_16x16x32_bf16 v[96:99], v[132:135], v[84:87], 0
  ds_write_b64 v141, v[36:37] offset:2048
  v_mfma_f32_16x16x32_bf16 v[100:103], v[130:133], v[84:87], 0
  v_cvt_pk_bf16_f32 v56, v56, v57
  v_mfma_f32_16x16x32_bf16 v[104:107], v[132:135], v[88:91], 0
  v_cvt_pk_bf16_f32 v57, v58, v59
  ds_write_b64 v142, v[56:57] offset:2048
  v_mfma_f32_16x16x32_bf16 v[108:111], v[130:133], v[88:91], 0
  v_cvt_pk_bf16_f32 v76, v76, v77
  s_waitcnt vmcnt(2)
  v_mfma_f32_16x16x32_bf16 v[96:99], v[132:135], v[116:119], v[96:99]
  v_cvt_pk_bf16_f32 v77, v78, v79
  v_mfma_f32_16x16x32_bf16 v[100:103], v[130:133], v[116:119], v[100:103]
  ds_write_b64 v143, v[76:77] offset:2048
  v_cvt_pk_bf16_f32 v16, v16, v17
  s_waitcnt vmcnt(1)
  v_mfma_f32_16x16x32_bf16 v[104:107], v[132:135], v[120:123], v[104:107]
  v_cvt_pk_bf16_f32 v17, v18, v19
  v_mfma_f32_16x16x32_bf16 v[108:111], v[130:133], v[120:123], v[108:111]
  ds_write_b64 v140, v[16:17] offset:2048
  s_waitcnt vmcnt(0)
  v_mfma_f32_16x16x32_bf16 v[124:127], v[136:139], v[112:115], 0
  s_waitcnt lgkmcnt(0)
  s_barrier
  ds_read_b64 v[20:21], v144 offset:0
  ds_read_b64 v[22:23], v144 offset:2560
  ds_read_b64 v[40:41], v144 offset:5120
  ds_read_b64 v[42:43], v144 offset:7680
  ds_read_b64 v[24:25], v144 offset:512
  ds_read_b64 v[26:27], v144 offset:3072
  ds_read_b64 v[44:45], v144 offset:5632
  ds_read_b64 v[46:47], v144 offset:8192
  ds_read_b64 v[28:29], v144 offset:1024
  ds_read_b64 v[30:31], v144 offset:3584
  ds_read_b64 v[48:49], v144 offset:6144
  ds_read_b64 v[50:51], v144 offset:8704
  ds_read_b64 v[32:33], v144 offset:1536
  ds_read_b64 v[34:35], v144 offset:4096
  ds_read_b64 v[52:53], v144 offset:6656
  ds_read_b64 v[54:55], v144 offset:9216
  ds_read_b64 v[36:37], v144 offset:2048
  ds_read_b64 v[38:39], v144 offset:4608
  ds_read_b64 v[56:57], v144 offset:7168
  ds_read_b64 v[58:59], v144 offset:9728
  s_waitcnt lgkmcnt(15)
  v_mfma_f32_16x16x32_bf16 v[96:99], v[136:139], v[20:23], v[96:99]
  s_waitcnt lgkmcnt(14)
  v_mfma_f32_16x16x32_bf16 v[100:103], v[136:139], v[24:27], v[100:103]
  v_mfma_f32_16x16x32_bf16 v[96:99], v[136:139], v[40:43], v[96:99]
  s_waitcnt lgkmcnt(12)
  v_mfma_f32_16x16x32_bf16 v[100:103], v[136:139], v[44:47], v[100:103]
  s_waitcnt lgkmcnt(10)
  v_mfma_f32_16x16x32_bf16 v[104:107], v[136:139], v[28:31], v[104:107]
  s_waitcnt lgkmcnt(6)
  v_mfma_f32_16x16x32_bf16 v[108:111], v[136:139], v[32:35], v[108:111]
  v_mfma_f32_16x16x32_bf16 v[104:107], v[136:139], v[48:51], v[104:107]
  s_waitcnt lgkmcnt(4)
  v_mfma_f32_16x16x32_bf16 v[108:111], v[136:139], v[52:55], v[108:111]
  s_waitcnt lgkmcnt(2)
  v_mfma_f32_16x16x32_bf16 v[124:127], v[136:139], v[36:39], v[124:127]
  v_cvt_pk_bf16_f32 v84, v96, v97
  v_cvt_pk_bf16_f32 v85, v98, v99
  v_cvt_pk_bf16_f32 v86, v100, v101
  v_cvt_pk_bf16_f32 v87, v102, v103
  buffer_store_dwordx4 v[84:87], v94, s[12:15], 0 offen sc1
  s_waitcnt lgkmcnt(0)
  v_mfma_f32_16x16x32_bf16 v[124:127], v[136:139], v[56:59], v[124:127]
  v_cvt_pk_bf16_f32 v88, v104, v105
  v_cvt_pk_bf16_f32 v89, v106, v107
  v_cvt_pk_bf16_f32 v90, v108, v109
  v_cvt_pk_bf16_f32 v91, v110, v111
  buffer_store_dwordx4 v[88:91], v94, s[12:15], 0 offen offset:64 sc1
  s_nop 2
  v_cvt_pk_bf16_f32 v92, v124, v125
  v_cvt_pk_bf16_f32 v93, v126, v127
  buffer_store_dwordx2 v[92:93], v95, s[12:15], 0 offen sc1
  s_endpgm
L_k2_kernel_tg14_no:
  s_add_u32 s37, s37, 1
  s_cmp_gt_u32 s37, 200000
  s_cbranch_scc1 L_k2_kernel_tg14_ok
  s_add_u32 s44, s40, 55296
  buffer_load_dwordx4 a[0:3], v80, s[8:11], s44 offen sc1
  s_add_u32 s44, s41, 55296
  buffer_load_dwordx4 a[4:7], v80, s[8:11], s44 offen sc1
  s_add_u32 s44, s42, 55296
  buffer_load_dwordx4 a[8:11], v80, s[8:11], s44 offen sc1
  s_add_u32 s44, s43, 55296
  buffer_load_dwordx4 a[12:15], v80, s[8:11], s44 offen sc1
  s_waitcnt vmcnt(0)
  v_accvgpr_read_b32 v92, a0
  v_accvgpr_read_b32 v93, a4
  v_accvgpr_read_b32 v129, a8
  v_accvgpr_read_b32 v82, a12
  v_max3_u32 v92, v92, v93, v129
  v_max_u32 v92, v92, v82
  v_cmp_eq_u32 vcc, -1, v92
  s_nop 0
  s_cbranch_vccnz L_k2_kernel_tg14_no
  s_branch L_k2_kernel_tg14_ok
L_k2_kernel_tg15_no:
  s_add_u32 s37, s37, 1
  s_cmp_gt_u32 s37, 200000
  s_cbranch_scc1 L_k2_kernel_tg15_ok
  s_add_u32 s44, s40, 59392
  buffer_load_dwordx4 a[36:39], v80, s[8:11], s44 offen sc1
  s_add_u32 s44, s41, 59392
  buffer_load_dwordx4 a[40:43], v80, s[8:11], s44 offen sc1
  s_add_u32 s44, s42, 59392
  buffer_load_dwordx4 a[44:47], v80, s[8:11], s44 offen sc1
  s_add_u32 s44, s43, 59392
  buffer_load_dwordx4 a[48:51], v80, s[8:11], s44 offen sc1
  s_waitcnt vmcnt(0)
  v_accvgpr_read_b32 v92, a36
  v_accvgpr_read_b32 v93, a40
  v_accvgpr_read_b32 v129, a44
  v_accvgpr_read_b32 v82, a48
  v_max3_u32 v92, v92, v93, v129
  v_max_u32 v92, v92, v82
  v_cmp_eq_u32 vcc, -1, v92
  s_nop 0
  s_cbranch_vccnz L_k2_kernel_tg15_no
  s_branch L_k2_kernel_tg15_ok
L_k2_kernel_tg16_no:
  s_add_u32 s37, s37, 1
  s_cmp_gt_u32 s37, 200000
  s_cbranch_scc1 L_k2_kernel_tg16_ok
  s_add_u32 s44, s40, 63488
  buffer_load_dwordx4 a[72:75], v80, s[8:11], s44 offen sc1
  s_add_u32 s44, s41, 63488
  buffer_load_dwordx4 a[76:79], v80, s[8:11], s44 offen sc1
  s_add_u32 s44, s42, 63488
  buffer_load_dwordx4 a[80:83], v80, s[8:11], s44 offen sc1
  s_add_u32 s44, s43, 63488
  buffer_load_dwordx4 a[84:87], v80, s[8:11], s44 offen sc1
  s_waitcnt vmcnt(0)
  v_accvgpr_read_b32 v92, a72
  v_accvgpr_read_b32 v93, a76
  v_accvgpr_read_b32 v129, a80
  v_accvgpr_read_b32 v82, a84
  v_max3_u32 v92, v92, v93, v129
  v_max_u32 v92, v92, v82
  v_cmp_eq_u32 vcc, -1, v92
  s_nop 0
  s_cbranch_vccnz L_k2_kernel_tg16_no
  s_branch L_k2_kernel_tg16_ok
L_k2_kernel_tg17_no:
  s_add_u32 s37, s37, 1
  s_cmp_gt_u32 s37, 200000
  s_cbranch_scc1 L_k2_kernel_tg17_ok
  s_add_u32 s44, s40, 67584
  buffer_load_dwordx4 a[0:3], v80, s[8:11], s44 offen sc1
  s_add_u32 s44, s41, 67584
  buffer_load_dwordx4 a[4:7], v80, s[8:11], s44 offen sc1
  s_add_u32 s44, s42, 67584
  buffer_load_dwordx4 a[8:11], v80, s[8:11], s44 offen sc1
  s_add_u32 s44, s43, 67584
  buffer_load_dwordx4 a[12:15], v80, s[8:11], s44 offen sc1
  s_waitcnt vmcnt(0)
  v_accvgpr_read_b32 v92, a0
  v_accvgpr_read_b32 v93, a4
  v_accvgpr_read_b32 v129, a8
  v_accvgpr_read_b32 v82, a12
  v_max3_u32 v92, v92, v93, v129
  v_max_u32 v92, v92, v82
  v_cmp_eq_u32 vcc, -1, v92
  s_nop 0
  s_cbranch_vccnz L_k2_kernel_tg17_no
  s_branch L_k2_kernel_tg17_ok
L_k2_kernel_tg18_no:
  s_add_u32 s37, s37, 1
  s_cmp_gt_u32 s37, 200000
  s_cbranch_scc1 L_k2_kernel_tg18_ok
  s_add_u32 s44, s40, 71680
  buffer_load_dwordx2 v[96:97], v126, s[8:11], s44 offen sc1
  buffer_load_dwordx2 v[98:99], v126, s[8:11], s44 offen offset:512 sc1
  s_add_u32 s44, s41, 71680
  buffer_load_dwordx2 v[100:101], v126, s[8:11], s44 offen sc1
  buffer_load_dwordx2 v[102:103], v126, s[8:11], s44 offen offset:512 sc1
  s_add_u32 s44, s42, 71680
  buffer_load_dwordx2 v[104:105], v126, s[8:11], s44 offen sc1
  buffer_load_dwordx2 v[106:107], v126, s[8:11], s44 offen offset:512 sc1
  s_add_u32 s44, s43, 71680
  buffer_load_dwordx2 v[108:109], v126, s[8:11], s44 offen sc1
  buffer_load_dwordx2 v[110:111], v126, s[8:11], s44 offen offset:512 sc1
  s_waitcnt vmcnt(0)
  v_max3_u32 v92, v96, v98, v100
  v_max3_u32 v93, v102, v104, v106
  v_max3_u32 v92, v92, v108, v110
  v_max_u32 v92, v92, v93
  v_cmp_eq_u32 vcc, -1, v92
  s_nop 0
  s_cbranch_vccnz L_k2_kernel_tg18_no
  s_branch L_k2_kernel_tg18_ok
L_k2_kernel_att:
  s_setprio 1
  s_lshl_b32 s23, s26, 8
  s_lshl_b32 s24, s22, 6
  s_add_u32 s23, s23, s24
  s_lshl_b32 s23, s23, 4
  s_lshl_b32 s24, s30, 15
  s_add_u32 s39, s23, s24
  s_add_u32 s39, s39, 14680064
  v_lshlrev_b32 v11, 4, v15
  s_add_u32 s23, s39, 2621440
  v_add_u32 v1, s23, v11
  s_lshl_b32 s23, s22, 10
  s_add_u32 s52, s23, 12480
  v_add_u32 v11, s23, v11
  s_mov_b32 s50, 32768
  s_mov_b32 s51, 65536
  buffer_load_dwordx4 v[36:39], v1, s[8:11], 0 offen
  buffer_load_dwordx4 v[40:43], v1, s[8:11], s50 offen
  buffer_load_dwordx4 v[44:47], v1, s[8:11], s51 offen
  s_barrier
  s_add_u32 m0, s52, 0
  s_mov_b32 s23, 2621440
  buffer_load_dwordx4 v1, s[8:11], s23 offen lds
  s_add_u32 m0, s52, 4160
  s_mov_b32 s23, 2654208
  buffer_load_dwordx4 v1, s[8:11], s23 offen lds
  s_add_u32 m0, s52, 8320
  s_mov_b32 s23, 2686976
  buffer_load_dwordx4 v1, s[8:11], s23 offen lds
  v_and_b32 v16, 15, v15
  v_lshrrev_b32 v17, 4, v15
  v_mov_b32 v80, 1073741824
  v_lshlrev_b32 v60, 15, v17
  v_lshl_add_u32 v60, v16, 4, v60
  v_add_u32 v60, s39, v60
  v_cmp_gt_u32 vcc, 3, v17
  s_nop 1
  v_cndmask_b32 v2, v80, v60, vcc
  s_mov_b32 s40, 0x358637bd
  s_mov_b32 s41, 0x358637bd
  s_mov_b32 s42, 0x3f317218
  s_mov_b32 s43, 0x3f317218
  s_cmp_eq_u32 s29, 1
  s_cselect_b32 s35, 0, -1
  s_cselect_b32 s36, -1, 0
  v_mov_b32 v14, 1
  v_mov_b32 v13, 31744
  s_and_b32 s23, s22, 1
  s_lshr_b32 s24, s22, 1
  s_cmp_eq_u32 s23, 1
  s_cselect_b32 s32, 9, 10
  s_lshl_b32 s32, s24, s32
  s_lshl_b32 s31, s23, 11
  s_add_u32 s32, s32, s31
  s_cmp_eq_u32 s23, 1
  s_cselect_b32 s31, 32, 64
  s_mul_i32 s34, s25, 24576
  s_add_u32 s32, s32, s34
  s_add_u32 s32, s32, 23134208
  v_lshlrev_b32 v60, 4, v15
  v_add_u32 v60, s32, v60
  v_cmp_gt_u32 vcc, s31, v15
  s_nop 1
  v_cndmask_b32 v4, v80, v60, vcc
  s_mul_i32 s32, s26, 3072
  v_add_u32 v60, s32, v60
  v_cndmask_b32 v3, v80, v60, vcc
  s_lshl_b32 s32, s24, 4
  v_add_u32 v60, s32, v16
  v_cmp_ge_u32 s[46:47], 24, v60
  v_mul_u32_u24 v60, 48, v60
  s_lshl_b32 s32, s23, 5
  v_lshl_add_u32 v60, v17, 3, v60
  v_add_u32 v60, s32, v60
  v_add_u32 v60, 29184, v60
  v_lshlrev_b32 v61, 3, v15
  v_add_u32 v62, 30720, v61
  v_cndmask_b32 v60, v62, v60, s[46:47]
  v_add_u32 v61, 30144, v61
  s_cmp_eq_u32 s22, 3
  s_cbranch_scc1 L_k2_kernel_kw3
  v_mov_b32 v61, v62
L_k2_kernel_kw3:
  v_cndmask_b32 v12, v61, v60, vcc
  s_mul_i32 s32, s25, 24576
  s_add_u32 s32, s32, 23134204
  s_and_b32 s34, s22, 1
  s_lshl_b32 s46, s34, 11
  s_add_u32 s32, s32, s46
  s_sub_u32 s46, 10, s34
  s_lshr_b32 s34, s22, 1
  s_add_u32 s34, s34, 1
  s_lshl_b32 s34, s34, s46
  s_add_u32 s32, s32, s34
  v_mul_u32_u24 v60, 3072, v15
  v_add_u32 v60, s32, v60
  v_cmp_gt_u32 vcc, 8, v15
  s_nop 1
  v_cndmask_b32 v18, v80, v60, vcc
  v_bfe_u32 v60, v15, 2, 2
  v_lshl_add_u32 v60, v17, 3, v60
  v_lshlrev_b32 v60, 4, v60
  v_and_b32 v61, 1, v15
  v_lshl_add_u32 v60, v61, 3, v60
  v_bfe_u32 v61, v15, 1, 1
  s_lshl_b32 s23, s23, 1
  v_add_u32 v62, s23, v61
  v_min_u32 v62, 2, v62
  v_mul_u32_u24 v62, 4160, v62
  v_add_u32 v9, v62, v60
  s_lshl_b32 s24, s24, 1
  v_add_u32 v62, s24, v61
  v_mul_u32_u24 v62, 4160, v62
  v_add_u32 v62, 12480, v62
  v_add_u32 v10, v62, v60
  v_mov_b32 v62, 30400
  v_cmp_gt_u32 vcc, 3, v17
  v_lshlrev_b32 v63, 4, v17
  v_add_u32 v63, 30336, v63
  v_cndmask_b32 v6, v62, v63, vcc
  s_lshl_b32 s23, s26, 2
  s_add_u32 s23, s23, s22
  s_lshl_b32 s23, s23, 7
  s_lshl_b32 s24, s25, 2
  s_add_u32 s23, s23, s24
  s_add_u32 s23, s23, 24117248
  v_mov_b32 v60, s23
  v_cmp_eq_u32 vcc, 0, v15
  s_nop 1
  v_cndmask_b32 v8, v80, v60, vcc
  v_mov_b32 v60, 0x3f80
  v_mov_b32 v61, 0
  v_mov_b32 v62, 0
  v_mov_b32 v63, 0
  ds_write_b128 v11, v[60:63] offset:24960
  s_waitcnt vmcnt(5)
  v_lshlrev_b32 v60, 16, v36
  v_and_b32 v61, 0xffff0000, v36
  v_lshlrev_b32 v66, 16, v37
  v_and_b32 v67, 0xffff0000, v37
  v_lshlrev_b32 v72, 16, v38
  v_and_b32 v73, 0xffff0000, v38
  v_lshlrev_b32 v78, 16, v39
  v_and_b32 v79, 0xffff0000, v39
  v_exp_f32_e64 v62, v60 clamp
  v_exp_f32_e64 v63, v61 clamp
  v_exp_f32_e64 v68, v66 clamp
  v_exp_f32_e64 v69, v67 clamp
  v_exp_f32_e64 v74, v72 clamp
  v_exp_f32_e64 v75, v73 clamp
  v_exp_f32_e64 v80, v78 clamp
  v_exp_f32_e64 v81, v79 clamp
  v_pk_add_f32 v[62:63], v[62:63], s[40:41]
  v_pk_add_f32 v[68:69], v[68:69], s[40:41]
  v_pk_add_f32 v[74:75], v[74:75], s[40:41]
  v_pk_add_f32 v[80:81], v[80:81], s[40:41]
  v_pk_fma_f32 v[64:65], v[60:61], s[42:43], v[62:63]
  v_pk_fma_f32 v[70:71], v[66:67], s[42:43], v[68:69]
  v_pk_fma_f32 v[76:77], v[72:73], s[42:43], v[74:75]
  v_pk_fma_f32 v[82:83], v[78:79], s[42:43], v[80:81]
  v_max_f32 v64, v64, v62
  v_max_f32 v65, v65, v63
  v_max_f32 v70, v70, v68
  v_max_f32 v71, v71, v69
  v_max_f32 v76, v76, v74
  v_max_f32 v77, v77, v75
  v_max_f32 v82, v82, v80
  v_max_f32 v83, v83, v81
  v_cvt_pk_bf16_f32 v48, v64, v65
  v_cvt_pk_bf16_f32 v49, v70, v71
  v_cvt_pk_bf16_f32 v50, v76, v77
  v_cvt_pk_bf16_f32 v51, v82, v83
  s_waitcnt vmcnt(4)
  v_lshlrev_b32 v60, 16, v40
  v_and_b32 v61, 0xffff0000, v40
  v_lshlrev_b32 v66, 16, v41
  v_and_b32 v67, 0xffff0000, v41
  v_lshlrev_b32 v72, 16, v42
  v_and_b32 v73, 0xffff0000, v42
  v_lshlrev_b32 v78, 16, v43
  v_and_b32 v79, 0xffff0000, v43
  v_exp_f32_e64 v62, v60 clamp
  v_exp_f32_e64 v63, v61 clamp
  v_exp_f32_e64 v68, v66 clamp
  v_exp_f32_e64 v69, v67 clamp
  v_exp_f32_e64 v74, v72 clamp
  v_exp_f32_e64 v75, v73 clamp
  v_exp_f32_e64 v80, v78 clamp
  v_exp_f32_e64 v81, v79 clamp
  v_pk_add_f32 v[62:63], v[62:63], s[40:41]
  v_pk_add_f32 v[68:69], v[68:69], s[40:41]
  v_pk_add_f32 v[74:75], v[74:75], s[40:41]
  v_pk_add_f32 v[80:81], v[80:81], s[40:41]
  v_pk_fma_f32 v[64:65], v[60:61], s[42:43], v[62:63]
  v_pk_fma_f32 v[70:71], v[66:67], s[42:43], v[68:69]
  v_pk_fma_f32 v[76:77], v[72:73], s[42:43], v[74:75]
  v_pk_fma_f32 v[82:83], v[78:79], s[42:43], v[80:81]
  v_max_f32 v64, v64, v62
  v_max_f32 v65, v65, v63
  v_max_f32 v70, v70, v68
  v_max_f32 v71, v71, v69
  v_max_f32 v76, v76, v74
  v_max_f32 v77, v77, v75
  v_max_f32 v82, v82, v80
  v_max_f32 v83, v83, v81
  v_cvt_pk_bf16_f32 v52, v64, v65
  v_cvt_pk_bf16_f32 v53, v70, v71
  v_cvt_pk_bf16_f32 v54, v76, v77
  v_cvt_pk_bf16_f32 v55, v82, v83
  s_waitcnt vmcnt(3)
  v_lshlrev_b32 v60, 16, v44
  v_and_b32 v61, 0xffff0000, v44
  v_lshlrev_b32 v66, 16, v45
  v_and_b32 v67, 0xffff0000, v45
  v_lshlrev_b32 v72, 16, v46
  v_and_b32 v73, 0xffff0000, v46
  v_lshlrev_b32 v78, 16, v47
  v_and_b32 v79, 0xffff0000, v47
  v_exp_f32_e64 v62, v60 clamp
  v_exp_f32_e64 v63, v61 clamp
  v_exp_f32_e64 v68, v66 clamp
  v_exp_f32_e64 v69, v67 clamp
  v_exp_f32_e64 v74, v72 clamp
  v_exp_f32_e64 v75, v73 clamp
  v_exp_f32_e64 v80, v78 clamp
  v_exp_f32_e64 v81, v79 clamp
  v_pk_add_f32 v[62:63], v[62:63], s[40:41]
  v_pk_add_f32 v[68:69], v[68:69], s[40:41]
  v_pk_add_f32 v[74:75], v[74:75], s[40:41]
  v_pk_add_f32 v[80:81], v[80:81], s[40:41]
  v_pk_fma_f32 v[64:65], v[60:61], s[42:43], v[62:63]
  v_pk_fma_f32 v[70:71], v[66:67], s[42:43], v[68:69]
  v_pk_fma_f32 v[76:77], v[72:73], s[42:43], v[74:75]
  v_pk_fma_f32 v[82:83], v[78:79], s[42:43], v[80:81]
  v_max_f32 v64, v64, v62
  v_max_f32 v65, v65, v63
  v_max_f32 v70, v70, v68
  v_max_f32 v71, v71, v69
  v_max_f32 v76, v76, v74
  v_max_f32 v77, v77, v75
  v_max_f32 v82, v82, v80
  v_max_f32 v83, v83, v81
  v_cvt_pk_bf16_f32 v56, v64, v65
  v_cvt_pk_bf16_f32 v57, v70, v71
  v_cvt_pk_bf16_f32 v58, v76, v77
  v_cvt_pk_bf16_f32 v59, v82, v83
  v_and_b32 v48, s35, v48
  v_and_b32 v49, s35, v49
  v_and_b32 v58, s36, v58
  v_and_b32 v59, s36, v59
  ds_write_b128 v11, v[48:51] offset:0
  ds_write_b128 v11, v[52:55] offset:4160
  ds_write_b128 v11, v[56:59] offset:8320
  s_waitcnt vmcnt(0)
  buffer_load_dwordx4 v[20:23], v2, s[8:11], 0 offen offset:0
  buffer_load_dwordx4 v[24:27], v2, s[8:11], 0 offen offset:256
  buffer_load_dwordx4 v[28:31], v2, s[8:11], 0 offen offset:512
  buffer_load_dwordx4 v[32:35], v2, s[8:11], 0 offen offset:768
  s_waitcnt lgkmcnt(0)
  ds_add_u32 v13, v14 offset:0
  s_mov_b32 s37, 0
L_k2_kernel_s0:
  ds_read_b32 v60, v13 offset:0
  s_waitcnt lgkmcnt(0)
  v_readfirstlane_b32 s23, v60
  s_add_u32 s37, s37, 1
  s_cmp_ge_u32 s23, 256
  s_cbranch_scc1 L_k2_kernel_s0_ok
  s_cmp_lt_u32 s37, 1000000
  s_cbranch_scc1 L_k2_kernel_s0
L_k2_kernel_s0_ok:
  ds_read_b64_tr_b16 v[84:85], v9 offset:0
  ds_read_b64_tr_b16 v[86:87], v9 offset:64
  ds_read_b64_tr_b16 v[116:117], v10 offset:0
  ds_read_b64_tr_b16 v[118:119], v10 offset:64
  ds_read_b64_tr_b16 v[88:89], v9 offset:512
  ds_read_b64_tr_b16 v[90:91], v9 offset:576
  ds_read_b64_tr_b16 v[120:121], v10 offset:512
  ds_read_b64_tr_b16 v[122:123], v10 offset:576
  ds_read_b64_tr_b16 v[92:93], v9 offset:1024
  ds_read_b64_tr_b16 v[94:95], v9 offset:1088
  ds_read_b64_tr_b16 v[124:125], v10 offset:1024
  ds_read_b64_tr_b16 v[126:127], v10 offset:1088
  ds_read_b64_tr_b16 v[96:97], v9 offset:1536
  ds_read_b64_tr_b16 v[98:99], v9 offset:1600
  ds_read_b64_tr_b16 v[128:129], v10 offset:1536
  ds_read_b64_tr_b16 v[130:131], v10 offset:1600
  s_waitcnt lgkmcnt(12)
  v_mfma_f32_16x16x32_bf16 v[60:63], v[84:87], v[116:119], 0
  ds_read_b64_tr_b16 v[100:101], v9 offset:2048
  ds_read_b64_tr_b16 v[102:103], v9 offset:2112
  ds_read_b64_tr_b16 v[132:133], v10 offset:2048
  ds_read_b64_tr_b16 v[134:135], v10 offset:2112
  s_waitcnt lgkmcnt(12)
  v_mfma_f32_16x16x32_bf16 v[64:67], v[88:91], v[120:123], 0
  ds_read_b64_tr_b16 v[104:105], v9 offset:2560
  ds_read_b64_tr_b16 v[106:107], v9 offset:2624
  ds_read_b64_tr_b16 v[136:137], v10 offset:2560
  ds_read_b64_tr_b16 v[138:139], v10 offset:2624
  s_waitcnt lgkmcnt(12)
  v_mfma_f32_16x16x32_bf16 v[60:63], v[92:95], v[124:127], v[60:63]
  ds_read_b64_tr_b16 v[108:109], v9 offset:3072
  ds_read_b64_tr_b16 v[110:111], v9 offset:3136
  ds_read_b64_tr_b16 v[140:141], v10 offset:3072
  ds_read_b64_tr_b16 v[142:143], v10 offset:3136
  s_waitcnt lgkmcnt(12)
  v_mfma_f32_16x16x32_bf16 v[64:67], v[96:99], v[128:131], v[64:67]
  ds_read_b64_tr_b16 v[112:113], v9 offset:3584
  ds_read_b64_tr_b16 v[114:115], v9 offset:3648
  ds_read_b64_tr_b16 v[144:145], v10 offset:3584
  ds_read_b64_tr_b16 v[146:147], v10 offset:3648
  s_waitcnt lgkmcnt(12)
  v_mfma_f32_16x16x32_bf16 v[60:63], v[100:103], v[132:135], v[60:63]
  s_waitcnt lgkmcnt(8)
  v_mfma_f32_16x16x32_bf16 v[64:67], v[104:107], v[136:139], v[64:67]
  s_waitcnt lgkmcnt(4)
  v_mfma_f32_16x16x32_bf16 v[60:63], v[108:111], v[140:143], v[60:63]
  s_waitcnt lgkmcnt(0)
  v_mfma_f32_16x16x32_bf16 v[64:67], v[112:115], v[144:147], v[64:67]
  s_nop 7
  v_add_f32 v60, v60, v64
  v_add_f32 v61, v61, v65
  v_add_f32 v62, v62, v66
  v_add_f32 v63, v63, v67
  buffer_store_dwordx4 v[60:63], v3, s[8:11], 0 offen sc1
  s_nop 1
  v_lshrrev_b32 v60, 2, v16
  v_and_b32 v61, 1, v60
  v_add_u32 v61, s29, v61
  v_and_b32 v62, 3, v16
  v_lshl_add_u32 v61, v61, 3, v62
  v_mul_u32_u24 v61, 48, v61
  v_lshl_add_u32 v61, v17, 4, v61
  v_add_u32 v61, 29184, v61
  s_cmp_eq_u32 s29, 1
  s_cselect_b32 s23, 4, 16
  v_add_u32 v52, s23, v62
  v_mul_u32_u24 v52, 48, v52
  v_lshl_add_u32 v52, v17, 4, v52
  v_add_u32 v52, 29184, v52
  v_mov_b32 v62, 30400
  v_cmp_gt_u32 vcc, 3, v17
  s_nop 1
  v_cndmask_b32 v61, v62, v61, vcc
  v_cndmask_b32 v52, v62, v52, vcc
  v_cmp_gt_u32 vcc, 2, v60
  s_nop 1
  v_cndmask_b32 v48, v62, v61, vcc
  v_cndmask_b32 v49, v61, v62, vcc
  v_cmp_eq_u32 vcc, 3, v60
  s_nop 1
  v_cndmask_b32 v55, v62, v52, vcc
  v_cmp_eq_u32 vcc, 2, v60
  s_nop 1
  v_cndmask_b32 v54, v62, v52, vcc
  v_cmp_eq_u32 vcc, 1, v60
  s_nop 1
  v_cndmask_b32 v53, v62, v52, vcc
  v_cmp_eq_u32 vcc, 0, v60
  s_nop 1
  v_cndmask_b32 v52, v62, v52, vcc
  s_lshl_b32 s23, s26, 2
  s_add_u32 s23, s23, s22
  s_mul_i32 s23, s23, 303104
  s_add_u32 s23, s23, 55296
  s_lshl_b32 s24, s25, 1
  v_and_b32 v60, 1, v17
  v_add_u32 v60, s24, v60
  v_lshrrev_b32 v61, 2, v60
  v_lshlrev_b32 v61, 10, v61
  v_and_b32 v60, 3, v60
  v_lshl_add_u32 v60, v60, 4, v16
  v_lshl_add_u32 v60, v60, 4, v61
  v_lshrrev_b32 v61, 1, v17
  v_mul_u32_u24 v61, 75776, v61
  v_add3_u32 v7, v60, v61, s23
  s_lshl_b32 s24, s25, 7
  s_add_u32 s23, s23, s24
  s_add_u32 s23, s23, 16384
  v_mul_u32_u24 v61, 75776, v17
  v_lshl_add_u32 v61, v16, 3, v61
  v_add_u32 v50, s23, v61
  s_waitcnt vmcnt(4)
  v_lshlrev_b32 v68, 16, v20
  v_and_b32 v69, 0xffff0000, v20
  v_lshlrev_b32 v74, 16, v21
  v_and_b32 v75, 0xffff0000, v21
  v_lshlrev_b32 v80, 16, v22
  v_and_b32 v81, 0xffff0000, v22
  v_lshlrev_b32 v86, 16, v23
  v_and_b32 v87, 0xffff0000, v23
  v_exp_f32_e64 v70, v68 clamp
  v_exp_f32_e64 v71, v69 clamp
  v_exp_f32_e64 v76, v74 clamp
  v_exp_f32_e64 v77, v75 clamp
  v_exp_f32_e64 v82, v80 clamp
  v_exp_f32_e64 v83, v81 clamp
  v_exp_f32_e64 v88, v86 clamp
  v_exp_f32_e64 v89, v87 clamp
  v_pk_add_f32 v[70:71], v[70:71], s[40:41]
  v_pk_add_f32 v[76:77], v[76:77], s[40:41]
  v_pk_add_f32 v[82:83], v[82:83], s[40:41]
  v_pk_add_f32 v[88:89], v[88:89], s[40:41]
  v_pk_fma_f32 v[72:73], v[68:69], s[42:43], v[70:71]
  v_pk_fma_f32 v[78:79], v[74:75], s[42:43], v[76:77]
  v_pk_fma_f32 v[84:85], v[80:81], s[42:43], v[82:83]
  v_pk_fma_f32 v[90:91], v[86:87], s[42:43], v[88:89]
  v_max_f32 v72, v72, v70
  v_max_f32 v73, v73, v71
  v_max_f32 v78, v78, v76
  v_max_f32 v79, v79, v77
  v_max_f32 v84, v84, v82
  v_max_f32 v85, v85, v83
  v_max_f32 v90, v90, v88
  v_max_f32 v91, v91, v89
  v_cvt_pk_bf16_f32 v20, v72, v73
  v_cvt_pk_bf16_f32 v21, v78, v79
  v_cvt_pk_bf16_f32 v22, v84, v85
  v_cvt_pk_bf16_f32 v23, v90, v91
  s_waitcnt vmcnt(3)
  v_lshlrev_b32 v68, 16, v24
  v_and_b32 v69, 0xffff0000, v24
  v_lshlrev_b32 v74, 16, v25
  v_and_b32 v75, 0xffff0000, v25
  v_lshlrev_b32 v80, 16, v26
  v_and_b32 v81, 0xffff0000, v26
  v_lshlrev_b32 v86, 16, v27
  v_and_b32 v87, 0xffff0000, v27
  v_exp_f32_e64 v70, v68 clamp
  v_exp_f32_e64 v71, v69 clamp
  v_exp_f32_e64 v76, v74 clamp
  v_exp_f32_e64 v77, v75 clamp
  v_exp_f32_e64 v82, v80 clamp
  v_exp_f32_e64 v83, v81 clamp
  v_exp_f32_e64 v88, v86 clamp
  v_exp_f32_e64 v89, v87 clamp
  v_pk_add_f32 v[70:71], v[70:71], s[40:41]
  v_pk_add_f32 v[76:77], v[76:77], s[40:41]
  v_pk_add_f32 v[82:83], v[82:83], s[40:41]
  v_pk_add_f32 v[88:89], v[88:89], s[40:41]
  v_pk_fma_f32 v[72:73], v[68:69], s[42:43], v[70:71]
  v_pk_fma_f32 v[78:79], v[74:75], s[42:43], v[76:77]
  v_pk_fma_f32 v[84:85], v[80:81], s[42:43], v[82:83]
  v_pk_fma_f32 v[90:91], v[86:87], s[42:43], v[88:89]
  v_max_f32 v72, v72, v70
  v_max_f32 v73, v73, v71
  v_max_f32 v78, v78, v76
  v_max_f32 v79, v79, v77
  v_max_f32 v84, v84, v82
  v_max_f32 v85, v85, v83
  v_max_f32 v90, v90, v88
  v_max_f32 v91, v91, v89
  v_cvt_pk_bf16_f32 v24, v72, v73
  v_cvt_pk_bf16_f32 v25, v78, v79
  v_cvt_pk_bf16_f32 v26, v84, v85
  v_cvt_pk_bf16_f32 v27, v90, v91
  s_waitcnt vmcnt(2)
  v_lshlrev_b32 v68, 16, v28
  v_and_b32 v69, 0xffff0000, v28
  v_lshlrev_b32 v74, 16, v29
  v_and_b32 v75, 0xffff0000, v29
  v_lshlrev_b32 v80, 16, v30
  v_and_b32 v81, 0xffff0000, v30
  v_lshlrev_b32 v86, 16, v31
  v_and_b32 v87, 0xffff0000, v31
  v_exp_f32_e64 v70, v68 clamp
  v_exp_f32_e64 v71, v69 clamp
  v_exp_f32_e64 v76, v74 clamp
  v_exp_f32_e64 v77, v75 clamp
  v_exp_f32_e64 v82, v80 clamp
  v_exp_f32_e64 v83, v81 clamp
  v_exp_f32_e64 v88, v86 clamp
  v_exp_f32_e64 v89, v87 clamp
  v_pk_add_f32 v[70:71], v[70:71], s[40:41]
  v_pk_add_f32 v[76:77], v[76:77], s[40:41]
  v_pk_add_f32 v[82:83], v[82:83], s[40:41]
  v_pk_add_f32 v[88:89], v[88:89], s[40:41]
  v_pk_fma_f32 v[72:73], v[68:69], s[42:43], v[70:71]
  v_pk_fma_f32 v[78:79], v[74:75], s[42:43], v[76:77]
  v_pk_fma_f32 v[84:85], v[80:81], s[42:43], v[82:83]
  v_pk_fma_f32 v[90:91], v[86:87], s[42:43], v[88:89]
  v_max_f32 v72, v72, v70
  v_max_f32 v73, v73, v71
  v_max_f32 v78, v78, v76
  v_max_f32 v79, v79, v77
  v_max_f32 v84, v84, v82
  v_max_f32 v85, v85, v83
  v_max_f32 v90, v90, v88
  v_max_f32 v91, v91, v89
  v_cvt_pk_bf16_f32 v28, v72, v73
  v_cvt_pk_bf16_f32 v29, v78, v79
  v_cvt_pk_bf16_f32 v30, v84, v85
  v_cvt_pk_bf16_f32 v31, v90, v91
  s_waitcnt vmcnt(1)
  v_lshlrev_b32 v68, 16, v32
  v_and_b32 v69, 0xffff0000, v32
  v_lshlrev_b32 v74, 16, v33
  v_and_b32 v75, 0xffff0000, v33
  v_lshlrev_b32 v80, 16, v34
  v_and_b32 v81, 0xffff0000, v34
  v_lshlrev_b32 v86, 16, v35
  v_and_b32 v87, 0xffff0000, v35
  v_exp_f32_e64 v70, v68 clamp
  v_exp_f32_e64 v71, v69 clamp
  v_exp_f32_e64 v76, v74 clamp
  v_exp_f32_e64 v77, v75 clamp
  v_exp_f32_e64 v82, v80 clamp
  v_exp_f32_e64 v83, v81 clamp
  v_exp_f32_e64 v88, v86 clamp
  v_exp_f32_e64 v89, v87 clamp
  v_pk_add_f32 v[70:71], v[70:71], s[40:41]
  v_pk_add_f32 v[76:77], v[76:77], s[40:41]
  v_pk_add_f32 v[82:83], v[82:83], s[40:41]
  v_pk_add_f32 v[88:89], v[88:89], s[40:41]
  v_pk_fma_f32 v[72:73], v[68:69], s[42:43], v[70:71]
  v_pk_fma_f32 v[78:79], v[74:75], s[42:43], v[76:77]
  v_pk_fma_f32 v[84:85], v[80:81], s[42:43], v[82:83]
  v_pk_fma_f32 v[90:91], v[86:87], s[42:43], v[88:89]
  v_max_f32 v72, v72, v70
  v_max_f32 v73, v73, v71
  v_max_f32 v78, v78, v76
  v_max_f32 v79, v79, v77
  v_max_f32 v84, v84, v82
  v_max_f32 v85, v85, v83
  v_max_f32 v90, v90, v88
  v_max_f32 v91, v91, v89
  v_cvt_pk_bf16_f32 v32, v72, v73
  v_cvt_pk_bf16_f32 v33, v78, v79
  v_cvt_pk_bf16_f32 v34, v84, v85
  v_cvt_pk_bf16_f32 v35, v90, v91
  s_mov_b32 s37, 0
L_k2_kernel_pl:
  s_mov_b32 s23, 0
  buffer_load_dwordx4 v[84:87], v4, s[8:11], s23 offen sc1
  s_mov_b32 s23, 3072
  buffer_load_dwordx4 v[88:91], v4, s[8:11], s23 offen sc1
  s_mov_b32 s23, 6144
  buffer_load_dwordx4 v[92:95], v4, s[8:11], s23 offen sc1
  s_mov_b32 s23, 9216
  buffer_load_dwordx4 v[96:99], v4, s[8:11], s23 offen sc1
  s_mov_b32 s23, 12288
  buffer_load_dwordx4 v[100:103], v4, s[8:11], s23 offen sc1
  s_mov_b32 s23, 15360
  buffer_load_dwordx4 v[104:107], v4, s[8:11], s23 offen sc1
  s_mov_b32 s23, 18432
  buffer_load_dwordx4 v[108:111], v4, s[8:11], s23 offen sc1
  s_mov_b32 s23, 21504
  buffer_load_dwordx4 v[112:115], v4, s[8:11], s23 offen sc1
  s_waitcnt vmcnt(7)
  v_max3_u32 v116, v84, v85, v86
  v_max_u32 v116, v116, v87
  s_waitcnt vmcnt(6)
  v_max3_u32 v117, v88, v89, v90
  v_max_u32 v117, v117, v91
  s_waitcnt vmcnt(5)
  v_max3_u32 v118, v92, v93, v94
  v_max_u32 v118, v118, v95
  s_waitcnt vmcnt(4)
  v_max3_u32 v119, v96, v97, v98
  v_max_u32 v119, v119, v99
  s_waitcnt vmcnt(3)
  v_max3_u32 v120, v100, v101, v102
  v_max_u32 v120, v120, v103
  s_waitcnt vmcnt(2)
  v_max3_u32 v121, v104, v105, v106
  v_max_u32 v121, v121, v107
  s_waitcnt vmcnt(1)
  v_max3_u32 v122, v108, v109, v110
  v_max_u32 v122, v122, v111
  s_waitcnt vmcnt(0)
  v_max3_u32 v123, v112, v113, v114
  v_max_u32 v123, v123, v115
  v_max3_u32 v116, v116, v117, v118
  v_max3_u32 v119, v119, v120, v121
  v_max3_u32 v116, v116, v122, v123
  v_max_u32 v116, v116, v119
  v_cmp_eq_u32 vcc, -1, v116
  s_add_u32 s37, s37, 1
  s_cmp_eq_u64 vcc, 0
  s_cbranch_scc1 L_k2_kernel_pl_ok
  s_cmp_lt_u32 s37, 100000
  s_cbranch_scc1 L_k2_kernel_pl
L_k2_kernel_pl_ok:
  v_add_f32 v84, v84, v88
  v_add_f32 v85, v85, v89
  v_add_f32 v86, v86, v90
  v_add_f32 v87, v87, v91
  v_add_f32 v92, v92, v96
  v_add_f32 v93, v93, v97
  v_add_f32 v94, v94, v98
  v_add_f32 v95, v95, v99
  v_add_f32 v100, v100, v104
  v_add_f32 v101, v101, v105
  v_add_f32 v102, v102, v106
  v_add_f32 v103, v103, v107
  v_add_f32 v108, v108, v112
  v_add_f32 v109, v109, v113
  v_add_f32 v110, v110, v114
  v_add_f32 v111, v111, v115
  v_add_f32 v84, v84, v92
  v_add_f32 v85, v85, v93
  v_add_f32 v86, v86, v94
  v_add_f32 v87, v87, v95
  v_add_f32 v100, v100, v108
  v_add_f32 v101, v101, v109
  v_add_f32 v102, v102, v110
  v_add_f32 v103, v103, v111
  v_add_f32 v84, v84, v100
  v_add_f32 v85, v85, v101
  v_add_f32 v86, v86, v102
  v_add_f32 v87, v87, v103
  v_cvt_pk_bf16_f32 v88, v84, v85
  v_cvt_pk_bf16_f32 v89, v86, v87
  ds_write_b64 v12, v[88:89]
  s_waitcnt lgkmcnt(0)
  ds_add_u32 v13, v14 offset:4
  s_mov_b32 s37, 0
L_k2_kernel_s1:
  ds_read_b32 v60, v13 offset:4
  s_waitcnt lgkmcnt(0)
  v_readfirstlane_b32 s23, v60
  s_add_u32 s37, s37, 1
  s_cmp_ge_u32 s23, 256
  s_cbranch_scc1 L_k2_kernel_s1_ok
  s_cmp_lt_u32 s37, 1000000
  s_cbranch_scc1 L_k2_kernel_s1
L_k2_kernel_s1_ok:
  ds_read_b128 v[36:39], v6
  ds_read_b128 v[116:119], v48
  ds_read_b128 v[124:127], v49
  ds_read_b128 v[120:123], v48 offset:192
  ds_read_b128 v[128:131], v49 offset:192
  ds_read_b128 v[132:135], v52
  ds_read_b128 v[136:139], v53
  ds_read_b128 v[140:143], v54
  ds_read_b128 v[144:147], v55
  s_mov_b32 s51, 151552
  v_cmp_gt_u32 vcc, 32, v15
  v_and_b32 v100, 1, v17
  v_cmp_eq_u32 s[46:47], 0, v100
  s_waitcnt lgkmcnt(8)
  v_mfma_f32_16x16x32_bf16 v[60:63], v[36:39], v[20:23], 0
  v_mfma_f32_16x16x32_bf16 v[64:67], v[36:39], v[24:27], 0
  v_mfma_f32_16x16x32_bf16 v[68:71], v[36:39], v[28:31], 0
  v_mfma_f32_16x16x32_bf16 v[72:75], v[36:39], v[32:35], 0
  s_waitcnt lgkmcnt(7)
  v_mfma_f32_16x16x32_bf16 v[76:79], v[116:119], v[20:23], 0
  s_waitcnt lgkmcnt(5)
  v_mfma_f32_16x16x32_bf16 v[80:83], v[120:123], v[20:23], 0
  v_mfma_f32_16x16x32_bf16 v[84:87], v[116:119], v[28:31], 0
  v_mfma_f32_16x16x32_bf16 v[88:91], v[120:123], v[28:31], 0
  v_mfma_f32_16x16x32_bf16 v[76:79], v[124:127], v[24:27], v[76:79]
  s_waitcnt lgkmcnt(4)
  v_mfma_f32_16x16x32_bf16 v[80:83], v[128:131], v[24:27], v[80:83]
  v_mfma_f32_16x16x32_bf16 v[84:87], v[124:127], v[32:35], v[84:87]
  v_mfma_f32_16x16x32_bf16 v[88:91], v[128:131], v[32:35], v[88:91]
  s_waitcnt lgkmcnt(3)
  v_mfma_f32_16x16x32_bf16 v[92:95], v[132:135], v[20:23], 0
  s_waitcnt lgkmcnt(2)
  v_mfma_f32_16x16x32_bf16 v[92:95], v[136:139], v[24:27], v[92:95]
  s_waitcnt lgkmcnt(1)
  v_mfma_f32_16x16x32_bf16 v[92:95], v[140:143], v[28:31], v[92:95]
  s_waitcnt lgkmcnt(0)
  v_mfma_f32_16x16x32_bf16 v[92:95], v[144:147], v[32:35], v[92:95]
  v_cndmask_b32 v96, v64, v60, vcc
  v_cndmask_b32 v98, v72, v68, vcc
  v_cndmask_b32 v100, v64, v60, s[46:47]
  v_cndmask_b32 v101, v72, v68, s[46:47]
  v_cndmask_b32 v100, v101, v100, vcc
  v_add_f32 v96, 0x358637bd, v96
  v_add_f32 v98, 0x358637bd, v98
  v_add_f32 v100, 0x358637bd, v100
  v_rcp_f32 v96, v96
  v_rcp_f32 v98, v98
  v_rcp_f32 v100, v100
  v_mov_b32 v97, v96
  v_mov_b32 v99, v98
  v_mov_b32 v101, v100
  v_mul_f32 v76, v76, v96
  v_mul_f32 v77, v77, v97
  v_mul_f32 v78, v78, v96
  v_mul_f32 v79, v79, v97
  v_mul_f32 v80, v80, v96
  v_mul_f32 v81, v81, v97
  v_mul_f32 v82, v82, v96
  v_mul_f32 v83, v83, v97
  v_cvt_pk_bf16_f32 v104, v76, v77
  v_cvt_pk_bf16_f32 v105, v78, v79
  v_cvt_pk_bf16_f32 v106, v80, v81
  v_cvt_pk_bf16_f32 v107, v82, v83
  buffer_store_dwordx4 v[104:107], v7, s[8:11], 0 offen sc1
  v_mul_f32 v84, v84, v98
  v_mul_f32 v85, v85, v99
  v_mul_f32 v86, v86, v98
  v_mul_f32 v87, v87, v99
  v_mul_f32 v88, v88, v98
  v_mul_f32 v89, v89, v99
  v_mul_f32 v90, v90, v98
  v_mul_f32 v91, v91, v99
  v_cvt_pk_bf16_f32 v108, v84, v85
  v_cvt_pk_bf16_f32 v109, v86, v87
  v_cvt_pk_bf16_f32 v110, v88, v89
  v_cvt_pk_bf16_f32 v111, v90, v91
  buffer_store_dwordx4 v[108:111], v7, s[8:11], s51 offen sc1
  v_mul_f32 v92, v92, v100
  v_mul_f32 v93, v93, v101
  v_mul_f32 v94, v94, v100
  v_mul_f32 v95, v95, v101
  v_cvt_pk_bf16_f32 v112, v92, v93
  v_cvt_pk_bf16_f32 v113, v94, v95
  buffer_store_dwordx2 v[112:113], v50, s[8:11], 0 offen sc1
L_k2_kernel_end:
  s_endpgm
L_code_end:
.section .rodata,"a"
.p2align 6
.amdhsa_kernel k1_kernel
  .amdhsa_next_free_vgpr 512
  .amdhsa_next_free_sgpr 102
  .amdhsa_accum_offset 256
  .amdhsa_group_segment_fixed_size 0
  .amdhsa_kernarg_size 80
  .amdhsa_user_sgpr_count 2
  .amdhsa_user_sgpr_kernarg_segment_ptr 1
  .amdhsa_system_sgpr_workgroup_id_x 1
.end_amdhsa_kernel
.section .rodata,"a"
.p2align 6
.amdhsa_kernel k2_kernel
  .amdhsa_next_free_vgpr 256
  .amdhsa_next_free_sgpr 102
  .amdhsa_accum_offset 148
  .amdhsa_group_segment_fixed_size 0
  .amdhsa_kernarg_size 80
  .amdhsa_user_sgpr_count 2
  .amdhsa_user_sgpr_kernarg_segment_ptr 1
  .amdhsa_system_sgpr_workgroup_id_x 1
.end_amdhsa_kernel
```
